```python
import torch

def _softmax(x, axis=-1):
    return torch.softmax(x, dim=axis)
def _gelu(x):
    return torch.nn.functional.gelu(x, approximate="tanh")
def _silu(x):
    return torch.nn.functional.silu(x)
def _sigmoid(x):
    return torch.sigmoid(x)
def _layernorm(x, axis=-1, eps=1e-5):
    m = x.mean(dim=axis, keepdim=True)
    v = x.var(dim=axis, keepdim=True, unbiased=False)
    return (x - m) / torch.sqrt(v + eps)
def _scatter_add(tgt, idx, src, axis=0):
    return tgt.clone().index_add_(axis, idx, src)
def _segment_sum(src, seg, n):
    out = torch.zeros((n,) + src.shape[1:], dtype=src.dtype)
    return out.index_add_(0, seg, src)
def _pad(x, pw):
    flat = tuple(v for pair in reversed(pw) for v in pair)
    return torch.nn.functional.pad(x, flat)

kernel_name = 'sequential_preLN__sliding_block_cached__mixer_channel_mlp__decode'

def setup_inputs():

    _w = (lambda a: (lambda t: t.to(torch.bfloat16) if t.is_floating_point() else t)(torch.as_tensor(a)))
    def _A_setup():
        B, Sq, D = 4, 1, 448
        Hq, Hkv, Sk, Dh = 16, 8, 4096, 256
        assert Hq % Hkv == 0, (Hq, Hkv)
        return {
            "x": _w((lambda *s: torch.randn(*s, dtype=torch.bfloat16) * 0.05)(B, Sq, D)),
            "k_cache": _w((lambda *s: torch.randn(*s, dtype=torch.bfloat16) * 3.2)(B, Hkv, Sk, Dh)),
            "v_cache": _w((lambda *s: torch.randn(*s, dtype=torch.bfloat16) * 0.4)(B, Hkv, Sk, Dh)),
            "wq": _w((lambda *s: torch.randn(*s, dtype=torch.bfloat16) * 3.2)(D, Hq * Dh) * (D ** -0.5)),
            "wo": _w((lambda *s: torch.randn(*s, dtype=torch.bfloat16) * 0.4)(Hq * Dh, D) * ((Hq * Dh) ** -0.5)),
        }
    _A_in = _A_setup()

    def _B_setup():
        B, S, D, F = 4, 1, 448, 1792
        return {
            "x": _w((lambda *s: torch.randn(*s, dtype=torch.bfloat16) * 0.05)(B, S, D)),
            "w1": _w((lambda *s: torch.randn(*s, dtype=torch.bfloat16) * 3.2)(D, F) * (D ** -0.5)),
            "b1": _w((lambda *s: torch.randn(*s, dtype=torch.bfloat16) * 1.6)(F)),
            "w2": _w((lambda *s: torch.randn(*s, dtype=torch.bfloat16) * 0.1)(F, D) * (F ** -0.5)),
            "b2": _w((lambda *s: torch.randn(*s, dtype=torch.bfloat16) * 0.2)(D)),
        }
    _B_in = _B_setup()

    return {
        "A_x": _A_in["x"],
        "A_k_cache": _A_in["k_cache"],
        "A_v_cache": _A_in["v_cache"],
        "A_wq": _A_in["wq"],
        "A_wo": _A_in["wo"],
        "B_x": _B_in["x"],
        "B_w1": _B_in["w1"],
        "B_b1": _B_in["b1"],
        "B_w2": _B_in["w2"],
        "B_b2": _B_in["b2"],
    }

def reference(A_x, A_k_cache, A_v_cache, A_wq, A_wo, B_x, B_w1, B_b1, B_w2, B_b2):
    def _A_ref(x, k_cache, v_cache, wq, wo):
        B, Sq, D = x.shape
        Hq, Dh = 16, 256
        Hkv, Sk = k_cache.shape[1], k_cache.shape[2]
        W = min(4096, max(256, Sk // 4))
        rep = Hq // Hkv
        q = (lambda x, *d: x.permute(*d))((x @ wq).reshape(B, Sq, Hq, Dh), 0, 2, 1, 3)
        k = (lambda x, n, axis: torch.repeat_interleave(x, n, dim=axis))(k_cache[:, :, Sk - W:, :], rep, axis=1)
        v = (lambda x, n, axis: torch.repeat_interleave(x, n, dim=axis))(v_cache[:, :, Sk - W:, :], rep, axis=1)
        scores = torch.einsum("bhqd,bhkd->bhqk", q, k) * (Dh ** -0.5)
        p = _softmax(scores, axis=-1)
        o = torch.einsum("bhqk,bhkd->bhqd", p, v)
        return (lambda x, *d: x.permute(*d))(o, 0, 2, 1, 3).reshape(B, Sq, Hq * Dh) @ wo

    def _B_ref(x, w1, b1, w2, b2):
        y = _layernorm(x, axis=-1)
        h = _gelu(torch.einsum("bsd,df->bsf", y, w1) + b1)
        return torch.einsum("bsf,fd->bsd", h, w2) + b2

    x = A_x
    h = x + _A_ref(_layernorm(x, axis=-1), A_k_cache, A_v_cache, A_wq, A_wo)
    h2 = h + _B_ref(_layernorm(h, axis=-1), B_w1, B_b1, B_w2, B_b2)
    return h2
```

```asm
; @launch grid=(256,1,1) block=(576,1,1) lds=155648
.amdgcn_target "amdgcn-amd-amdhsa--gfx950"
.text
.globl sequential_preLN__sliding_block_cached__mixer_channel_mlp__decode_kernel
.p2align 12
.fill 832, 4, 0xbf810000
.p2align 8
.type sequential_preLN__sliding_block_cached__mixer_channel_mlp__decode_kernel,@function
sequential_preLN__sliding_block_cached__mixer_channel_mlp__decode_kernel:
    s_load_dwordx2 s[12:13], s[0:1], 24
    s_load_dwordx2 s[4:5], s[0:1], 8
    v_lshrrev_b32 v1, 6, v0
    v_and_b32 v0, 63, v0
    v_readfirstlane_b32 s3, v1
    s_load_dwordx2 s[20:21], s[0:1], 0
    s_load_dwordx2 s[16:17], s[0:1], 96
    s_load_dwordx2 s[8:9], s[0:1], 16
    s_cmp_ge_u32 s2, 256
    s_cbranch_scc1 L_end
    s_sub_u32 s52, s3, 5
    s_cmp_lt_u32 s52, 3
    s_cbranch_scc1 L_warm
L_warmdone:
    s_mov_b64 exec, -1
    s_mov_b32 s15, 0x20000
    s_mov_b32 s14, 3670016
    s_mov_b32 s7, s15
    s_mov_b32 s6, 0x4000000
    s_mov_b32 s23, s15
    s_movk_i32 s22, 3584
    s_mov_b32 s19, s15
    s_mov_b32 s18, 0x300000
    s_and_b32 s48, s2, 7
    s_lshr_b32 s49, s2, 3
    s_and_b32 s50, s3, 3
    v_and_b32 v5, 7, v0
    v_lshrrev_b32 v7, 4, v0
    v_lshlrev_b32 v5, 4, v5
    v_lshlrev_b32 v6, 5, v7
    v_xor_b32 v5, v5, v6
    v_lshrrev_b32 v6, 3, v0
    s_cmp_lt_u32 s3, 4
    s_cbranch_scc0 L_other
    v_lshl_add_u32 v10, v6, 13, v5
    s_lshr_b32 s52, s49, 3
    s_lshl_b32 s52, s52, 2
    s_add_u32 s52, s52, s50
    s_lshl_b32 s52, s52, 18
    s_lshl_b32 s53, s48, 10
    s_add_u32 s52, s52, s53
    s_and_b32 s53, s49, 7
    s_lshl_b32 s53, s53, 7
    s_add_u32 s52, s52, s53
    s_lshl_b32 s56, s50, 12
    s_add_u32 m0, s56, 4096
    v_lshrrev_b32 v12, 5, v0
    v_xor_b32 v12, v12, v0
    v_lshlrev_b32 v12, 4, v12
    s_lshl_b32 s57, s50, 5
    v_xor_b32 v12, s57, v12
    v_xor_b32 v13, 0x80, v12
    s_and_b32 s53, s2, 31
    s_lshl_b32 s53, s53, 5
    s_lshr_b32 s54, s2, 5
    s_add_u32 s53, s53, s54
    s_add_u32 s53, s53, 24
    s_lshl_b32 s53, s53, 16
    s_lshl_b32 s58, s50, 10
    s_add_u32 s54, s53, s58
    s_lshl_b32 s59, s49, 12
    s_waitcnt lgkmcnt(0)
    buffer_load_dwordx4 v10, s[12:15], s52 offen offset:0 nt lds
    s_add_u32 s52, s52, 64512
    buffer_load_dwordx4 v10, s[12:15], s52 offen offset:1024 nt lds
    s_add_u32 s52, s52, 64512
    buffer_load_dwordx4 v10, s[12:15], s52 offen offset:2048 nt lds
    s_add_u32 s52, s52, 64512
    buffer_load_dwordx4 v10, s[12:15], s52 offen offset:3072 nt lds
    s_add_u32 m0, s58, 24576
    s_and_b32 s59, s59, 0xf000
    s_add_u32 s60, s54, s59
    buffer_load_dwordx4 v12, s[4:7], s60 offen nt lds
    s_addk_i32 s59, 0x1000
    s_add_u32 m0, s58, 28672
    s_and_b32 s59, s59, 0xf000
    s_add_u32 s60, s54, s59
    buffer_load_dwordx4 v13, s[4:7], s60 offen nt lds
    s_addk_i32 s59, 0x1000
    s_branch L_lcont
L_warm:
    s_cmp_eq_u32 s3, 5
    s_cbranch_scc0 L_warm2
    s_getpc_b64 s[24:25]
L_pc:
    s_mov_b32 s26, L_end-L_pc
    s_mov_b32 s27, 0x20000
    v_lshlrev_b32 v8, 7, v0
    s_movk_i32 s52, 0x2000
    buffer_load_dword v165, v8, s[24:27], 0 offen
    buffer_load_dword v165, v8, s[24:27], s52 offen
    s_mov_b64 exec, 0
    s_branch PADCHAIN_0
L_warm2:
    s_mov_b64 exec, 0
    s_cmp_eq_u32 s3, 6
    s_cbranch_scc1 PADCHAIN_1
    s_branch PADCHAIN_2
WB_0:
    s_barrier
    s_branch PADSECOND_0
WB_1:
    s_barrier
    s_branch PADSECOND_1
WB_2:
    s_barrier
    s_branch PADSECOND_2
L_other:
    v_mov_b32 v8, 0
    v_mov_b32 v9, 0
    v_lshlrev_b32 v10, 3, v0
    s_cmp_eq_u32 s3, 8
    s_cbranch_scc1 L_ahead
    s_mov_b32 s88, 0x80000
    v_mov_b32 v3, 3072
    s_lshl_b32 s51, s50, 2
    v_add_u32 v2, s51, v3
    v_mov_b32 v4, 1
    s_mov_b32 s11, s15
    s_mov_b32 s10, s6
    s_cmp_eq_u32 s3, 4
    s_cbranch_scc0 L_swave
    s_branch L_shead
L_ahead:
    s_setprio 3
    v_and_b32 v12, 15, v0
    v_mul_u32_u24 v13, 896, v7
    v_lshl_add_u32 v14, v12, 3, v13
    v_lshl_add_u32 v13, v12, 4, v13
    s_lshr_b32 s52, s49, 3
    s_lshl_b32 s53, s52, 8
    s_mov_b32 s54, 463104
    s_waitcnt lgkmcnt(0)
    buffer_load_dwordx4 v[16:19], v13, s[20:23], 0 offen
    buffer_load_dwordx4 v[20:23], v13, s[20:23], 0 offen offset:256
    buffer_load_dwordx4 v[24:27], v13, s[20:23], 0 offen offset:512
    buffer_load_dwordx2 v[28:29], v14, s[20:23], 0 offen offset:768
    buffer_load_dwordx4 v[30:33], v13, s[20:23], s53 offen
    buffer_load_dword v110, v8, s[16:19], s54 offen sc1
    s_branch L_awave
L_lcont:
    s_mov_b32 s88, 0x80000
    v_mov_b32 v3, 3072
    s_lshl_b32 s51, s50, 2
    v_add_u32 v2, s51, v3
    v_mov_b32 v4, 1
    s_mov_b32 s11, s15
    s_mov_b32 s10, s6
    v_lshl_add_u32 v11, v6, 9, v5
    s_lshl_b32 s55, s50, 14
    s_lshl_b32 s56, s50, 7
    s_add_u32 s53, s53, s56
    s_barrier
    s_waitcnt vmcnt(5)
    s_add_u32 m0, s58, 32768
    s_and_b32 s59, s59, 0xf000
    s_add_u32 s60, s54, s59
    buffer_load_dwordx4 v12, s[4:7], s60 offen nt lds
    s_addk_i32 s59, 0x1000
    s_waitcnt vmcnt(5)
    s_add_u32 m0, s58, 36864
    s_and_b32 s59, s59, 0xf000
    s_add_u32 s60, s54, s59
    buffer_load_dwordx4 v13, s[4:7], s60 offen nt lds
    s_addk_i32 s59, 0x1000
    s_waitcnt vmcnt(5)
    s_add_u32 m0, s58, 40960
    s_and_b32 s59, s59, 0xf000
    s_add_u32 s60, s54, s59
    buffer_load_dwordx4 v12, s[4:7], s60 offen nt lds
    s_addk_i32 s59, 0x1000
    s_waitcnt vmcnt(5)
    ds_write_b32 v2, v4 offset:0
    s_add_u32 m0, s58, 45056
    s_and_b32 s59, s59, 0xf000
    s_add_u32 s60, s54, s59
    buffer_load_dwordx4 v13, s[4:7], s60 offen nt lds
    s_addk_i32 s59, 0x1000
    s_waitcnt vmcnt(5)
    s_add_u32 m0, s58, 49152
    s_and_b32 s59, s59, 0xf000
    s_add_u32 s60, s54, s59
    buffer_load_dwordx4 v12, s[4:7], s60 offen nt lds
    s_addk_i32 s59, 0x1000
    s_waitcnt vmcnt(5)
    s_add_u32 m0, s58, 53248
    s_and_b32 s59, s59, 0xf000
PADCHAIN_0:
PAD_0:
    s_cbranch_execz WB_0
    s_add_u32 s60, s54, s59
    buffer_load_dwordx4 v13, s[4:7], s60 offen nt lds
    s_addk_i32 s59, 0x1000
    s_load_dwordx2 s[28:29], s[0:1], 32
    s_mov_b32 s30, 3670016
    s_mov_b32 s31, 0x20000
    s_lshl_b32 s66, s48, 5
    s_add_u32 s66, s66, s49
    s_lshl_b32 s66, s66, 2
    s_add_u32 s66, s66, s50
    s_mul_i32 s66, s66, 3584
    v_lshlrev_b32 v30, 7, v0
    s_waitcnt vmcnt(5)
    s_add_u32 m0, s58, 57344
    s_and_b32 s59, s59, 0xf000
    s_add_u32 s60, s54, s59
    buffer_load_dwordx4 v12, s[4:7], s60 offen nt lds
    s_addk_i32 s59, 0x1000
    s_waitcnt vmcnt(5)
    ds_write_b32 v2, v4 offset:128
    s_add_u32 m0, s58, 61440
    s_and_b32 s59, s59, 0xf000
    s_add_u32 s60, s54, s59
    buffer_load_dwordx4 v13, s[4:7], s60 offen nt lds
    s_addk_i32 s59, 0x1000
    s_waitcnt vmcnt(5)
    s_add_u32 m0, s58, 65536
    s_and_b32 s59, s59, 0xf000
    s_add_u32 s60, s54, s59
    buffer_load_dwordx4 v12, s[4:7], s60 offen nt lds
    s_addk_i32 s59, 0x1000
    s_waitcnt vmcnt(5)
    s_add_u32 m0, s58, 69632
    s_and_b32 s59, s59, 0xf000
    s_add_u32 s60, s54, s59
    buffer_load_dwordx4 v13, s[4:7], s60 offen nt lds
    s_addk_i32 s59, 0x1000
    s_waitcnt lgkmcnt(0)
    s_waitcnt vmcnt(5)
    s_add_u32 m0, s58, 73728
    s_and_b32 s59, s59, 0xf000
    s_add_u32 s60, s54, s59
    buffer_load_dwordx4 v12, s[4:7], s60 offen nt lds
    s_addk_i32 s59, 0x1000
    s_waitcnt vmcnt(5)
    ds_write_b32 v2, v4 offset:144
    s_add_u32 m0, s58, 77824
    s_and_b32 s59, s59, 0xf000
    s_add_u32 s60, s54, s59
    buffer_load_dwordx4 v13, s[4:7], s60 offen nt lds
    s_addk_i32 s59, 0x1000
    s_waitcnt vmcnt(5)
    s_add_u32 m0, s58, 81920
    s_and_b32 s59, s59, 0xf000
    s_add_u32 s60, s54, s59
    buffer_load_dwordx4 v12, s[4:7], s60 offen nt lds
    s_addk_i32 s59, 0x1000
    s_waitcnt vmcnt(5)
    s_add_u32 m0, s58, 86016
    s_and_b32 s59, s59, 0xf000
    s_add_u32 s60, s54, s59
    buffer_load_dwordx4 v13, s[4:7], s60 offen nt lds
    s_addk_i32 s59, 0x1000
    s_waitcnt vmcnt(5)
    s_branch L_pv
L_shead:
    v_mov_b32 v8, -1
    v_mov_b32 v9, -1
    v_mov_b32 v10, -1
    v_mov_b32 v11, -1
    v_mov_b32 v12, 0
    v_mov_b32 v13, 0
    v_lshlrev_b32 v15, 3, v0
    s_lshl_b32 s52, s48, 5
    s_add_u32 s52, s52, s49
    s_lshl_b32 s52, s52, 10
    s_add_u32 s52, s52, 917504
    v_lshlrev_b32 v14, 4, v0
    s_lshl_b32 s55, s2, 10
    s_add_u32 s55, s55, 1441792
    s_waitcnt lgkmcnt(0)
    buffer_store_dwordx4 v[8:11], v14, s[16:19], s52 offen
    s_sub_u32 s54, s49, 16
    s_cmp_lt_u32 s54, 16
    s_cbranch_scc1 L_noz
    s_mov_b64 exec, 0xffff
    buffer_store_dwordx2 v[12:13], v15, s[16:19], s55 offen sc1
    s_mov_b64 exec, -1
L_noz:
    s_barrier
    s_waitcnt vmcnt(0)
    ds_write_b32 v3, v4 offset:76
    v_lshlrev_b32 v16, 7, v0
    s_mov_b64 exec, 0xff
    buffer_load_dword v165, v16, s[16:19], s52 offen sc1
    s_mov_b64 exec, -1
    s_branch L_swave
L_awave:
    ds_write_b64 v10, v[8:9] offset:2560
    ds_write_b64 v10, v[8:9] offset:3072
    s_mov_b32 s88, 0x80000
    v_mov_b32 v3, 3072
    s_lshl_b32 s51, s50, 2
    v_add_u32 v2, s51, v3
    v_mov_b32 v4, 1
    s_mov_b32 s11, s15
    s_mov_b32 s10, s6
    s_waitcnt lgkmcnt(0)
    s_barrier
    s_mov_b32 s54, 4096
    v_lshrrev_b32 v104, 2, v0
    v_lshlrev_b32 v100, 7, v104
    v_and_b32 v105, 3, v0
    v_lshl_add_u32 v100, v105, 3, v100
    v_bfe_u32 v104, v0, 3, 2
    v_lshl_add_u32 v100, v104, 5, v100
    v_add_u32 v100, s54, v100
    v_xor_b32 v101, 32, v100
    v_xor_b32 v102, 64, v100
    v_xor_b32 v103, 0x60, v100
    v_bfe_u32 v104, v0, 2, 2
    v_lshlrev_b32 v104, 8, v104
    v_lshl_add_u32 v104, v7, 3, v104
    v_add_u32 v104, 0, v104
    v_lshlrev_b32 v106, 14, v7
    v_lshl_add_u32 v106, v12, 4, v106
    v_lshlrev_b32 v108, 4, v0
    s_mov_b32 s60, 0xffff0000
    v_mov_b32 v109, 0x3f803f80
    s_waitcnt vmcnt(1)
    v_dot2_f32_bf16 v72, v16, v109, 0
    v_dot2_f32_bf16 v73, v16, v16, 0
    v_dot2_f32_bf16 v72, v17, v109, v72
    v_dot2_f32_bf16 v73, v17, v17, v73
    v_dot2_f32_bf16 v72, v18, v109, v72
    v_dot2_f32_bf16 v73, v18, v18, v73
    v_dot2_f32_bf16 v72, v19, v109, v72
    v_dot2_f32_bf16 v73, v19, v19, v73
    v_dot2_f32_bf16 v72, v20, v109, v72
    v_dot2_f32_bf16 v73, v20, v20, v73
    v_dot2_f32_bf16 v72, v21, v109, v72
    v_dot2_f32_bf16 v73, v21, v21, v73
    v_dot2_f32_bf16 v72, v22, v109, v72
    v_dot2_f32_bf16 v73, v22, v22, v73
    v_dot2_f32_bf16 v72, v23, v109, v72
    v_dot2_f32_bf16 v73, v23, v23, v73
    v_dot2_f32_bf16 v72, v24, v109, v72
    v_dot2_f32_bf16 v73, v24, v24, v73
    v_dot2_f32_bf16 v72, v25, v109, v72
    v_dot2_f32_bf16 v73, v25, v25, v73
    v_dot2_f32_bf16 v72, v26, v109, v72
    v_dot2_f32_bf16 v73, v26, v26, v73
    v_dot2_f32_bf16 v72, v27, v109, v72
    v_dot2_f32_bf16 v73, v27, v27, v73
    v_dot2_f32_bf16 v72, v28, v109, v72
    v_dot2_f32_bf16 v73, v28, v28, v73
    v_dot2_f32_bf16 v72, v29, v109, v72
    v_dot2_f32_bf16 v73, v29, v29, v73
    v_lshlrev_b32 v64, 16, v30
    v_and_b32 v65, s60, v30
    v_lshlrev_b32 v66, 16, v31
PADCHAIN_1:
PAD_1:
    s_cbranch_execz WB_1
    v_and_b32 v67, s60, v31
    v_lshlrev_b32 v68, 16, v32
    v_and_b32 v69, s60, v32
    v_lshlrev_b32 v70, 16, v33
    v_and_b32 v71, s60, v33
    v_add_f32_dpp v72, v72, v72 row_ror:8 row_mask:0xf bank_mask:0xf
    v_add_f32_dpp v73, v73, v73 row_ror:8 row_mask:0xf bank_mask:0xf
    s_nop 0
    v_add_f32_dpp v72, v72, v72 row_ror:4 row_mask:0xf bank_mask:0xf
    v_add_f32_dpp v73, v73, v73 row_ror:4 row_mask:0xf bank_mask:0xf
    s_nop 0
    v_add_f32_dpp v72, v72, v72 row_ror:2 row_mask:0xf bank_mask:0xf
    v_add_f32_dpp v73, v73, v73 row_ror:2 row_mask:0xf bank_mask:0xf
    s_nop 0
    v_add_f32_dpp v72, v72, v72 row_ror:1 row_mask:0xf bank_mask:0xf
    v_add_f32_dpp v73, v73, v73 row_ror:1 row_mask:0xf bank_mask:0xf
    s_nop 0
    v_mul_f32 v72, 0x3b124925, v72
    v_mul_f32 v73, 0x3b124925, v73
    v_fma_f32 v73, -v72, v72, v73
    v_max_f32 v73, 0, v73
    v_cvt_pk_bf16_f32 v74, v72, v73
    v_lshlrev_b32 v72, 16, v74
    v_and_b32 v73, s60, v74
    v_add_f32 v73, 0x3727c5ac, v73
    v_cvt_pk_bf16_f32 v73, v73, v73
    v_and_b32 v73, s60, v73
    v_sqrt_f32 v73, v73
    s_nop 0
    v_cvt_pk_bf16_f32 v73, v73, v73
    v_and_b32 v73, s60, v73
    v_rcp_f32 v73, v73
    v_sub_f32 v64, v64, v72
    v_sub_f32 v65, v65, v72
    v_cvt_pk_bf16_f32 v74, v64, v65
    v_lshlrev_b32 v75, 16, v74
    v_and_b32 v76, s60, v74
    v_mul_f32 v75, v75, v73
    v_mul_f32 v76, v76, v73
    v_cvt_pk_bf16_f32 v30, v75, v76
    v_sub_f32 v66, v66, v72
    v_sub_f32 v67, v67, v72
    v_cvt_pk_bf16_f32 v74, v66, v67
    v_lshlrev_b32 v75, 16, v74
    v_and_b32 v76, s60, v74
    v_mul_f32 v75, v75, v73
    v_mul_f32 v76, v76, v73
    v_cvt_pk_bf16_f32 v31, v75, v76
    v_sub_f32 v68, v68, v72
    v_sub_f32 v69, v69, v72
    v_cvt_pk_bf16_f32 v74, v68, v69
    v_lshlrev_b32 v75, 16, v74
    v_and_b32 v76, s60, v74
    v_mul_f32 v75, v75, v73
    v_mul_f32 v76, v76, v73
    v_cvt_pk_bf16_f32 v32, v75, v76
    v_sub_f32 v70, v70, v72
    v_sub_f32 v71, v71, v72
    v_cvt_pk_bf16_f32 v74, v70, v71
    v_lshlrev_b32 v75, 16, v74
    v_and_b32 v76, s60, v74
    v_mul_f32 v75, v75, v73
    v_mul_f32 v76, v76, v73
    v_cvt_pk_bf16_f32 v33, v75, v76
    ds_write_b128 v108, v[30:33] offset:0
    ds_read2_b64 v[16:19], v104 offset0:0 offset1:4
    ds_read2_b64 v[20:23], v104 offset0:8 offset1:12
    ds_read2_b64 v[24:27], v104 offset0:16 offset1:20
    ds_read2_b64 v[28:31], v104 offset0:24 offset1:28
WF_3:
    s_sub_u32 s88, s88, 1
    s_cbranch_scc1 L_exit
    ds_read_b128 v[96:99], v3 offset:0
    s_waitcnt lgkmcnt(0)
    v_and_b32 v96, v96, v97
    v_and_b32 v98, v98, v99
    v_and_b32 v96, v96, v98
    v_cmp_ne_u32 vcc, 0, v96
    s_cbranch_vccz WF_3
    ds_read_b64_tr_b16 v[32:33], v100 offset:0
    ds_read_b64_tr_b16 v[34:35], v100 offset:2048
    ds_read_b64_tr_b16 v[36:37], v101 offset:0
    ds_read_b64_tr_b16 v[38:39], v101 offset:2048
    ds_read_b64_tr_b16 v[40:41], v102 offset:0
    ds_read_b64_tr_b16 v[42:43], v102 offset:2048
    ds_read_b64_tr_b16 v[44:45], v103 offset:0
    ds_read_b64_tr_b16 v[46:47], v103 offset:2048
    ds_read_b64_tr_b16 v[48:49], v100 offset:4096
    ds_read_b64_tr_b16 v[50:51], v100 offset:6144
    ds_read_b64_tr_b16 v[52:53], v101 offset:4096
    ds_read_b64_tr_b16 v[54:55], v101 offset:6144
    ds_read_b64_tr_b16 v[56:57], v102 offset:4096
    ds_read_b64_tr_b16 v[58:59], v102 offset:6144
    ds_read_b64_tr_b16 v[60:61], v103 offset:4096
    ds_read_b64_tr_b16 v[62:63], v103 offset:6144
    s_waitcnt lgkmcnt(0)
    v_mfma_f32_16x16x32_bf16 v[112:115], v[16:19], v[32:35], 0
    v_mfma_f32_16x16x32_bf16 v[116:119], v[16:19], v[36:39], 0
    v_mfma_f32_16x16x32_bf16 v[120:123], v[16:19], v[40:43], 0
    v_mfma_f32_16x16x32_bf16 v[124:127], v[16:19], v[44:47], 0
    v_mfma_f32_16x16x32_bf16 v[112:115], v[20:23], v[48:51], v[112:115]
    v_mfma_f32_16x16x32_bf16 v[116:119], v[20:23], v[52:55], v[116:119]
    v_mfma_f32_16x16x32_bf16 v[120:123], v[20:23], v[56:59], v[120:123]
    v_mfma_f32_16x16x32_bf16 v[124:127], v[20:23], v[60:63], v[124:127]
    ds_read_b64_tr_b16 v[64:65], v100 offset:8192
    ds_read_b64_tr_b16 v[66:67], v100 offset:10240
    ds_read_b64_tr_b16 v[68:69], v101 offset:8192
    ds_read_b64_tr_b16 v[70:71], v101 offset:10240
    ds_read_b64_tr_b16 v[72:73], v102 offset:8192
    ds_read_b64_tr_b16 v[74:75], v102 offset:10240
    ds_read_b64_tr_b16 v[76:77], v103 offset:8192
    ds_read_b64_tr_b16 v[78:79], v103 offset:10240
    ds_read_b64_tr_b16 v[80:81], v100 offset:12288
    ds_read_b64_tr_b16 v[82:83], v100 offset:14336
    ds_read_b64_tr_b16 v[84:85], v101 offset:12288
    ds_read_b64_tr_b16 v[86:87], v101 offset:14336
    ds_read_b64_tr_b16 v[88:89], v102 offset:12288
    ds_read_b64_tr_b16 v[90:91], v102 offset:14336
    ds_read_b64_tr_b16 v[92:93], v103 offset:12288
    ds_read_b64_tr_b16 v[94:95], v103 offset:14336
    s_waitcnt lgkmcnt(0)
    v_mfma_f32_16x16x32_bf16 v[112:115], v[24:27], v[64:67], v[112:115]
    v_mfma_f32_16x16x32_bf16 v[116:119], v[24:27], v[68:71], v[116:119]
    v_mfma_f32_16x16x32_bf16 v[120:123], v[24:27], v[72:75], v[120:123]
    v_mfma_f32_16x16x32_bf16 v[124:127], v[24:27], v[76:79], v[124:127]
    v_mfma_f32_16x16x32_bf16 v[112:115], v[28:31], v[80:83], v[112:115]
    v_mfma_f32_16x16x32_bf16 v[116:119], v[28:31], v[84:87], v[116:119]
    v_mfma_f32_16x16x32_bf16 v[120:123], v[28:31], v[88:91], v[120:123]
    v_mfma_f32_16x16x32_bf16 v[124:127], v[28:31], v[92:95], v[124:127]
WF_5:
    ds_read_b32 v8, v3 offset:76
    s_waitcnt lgkmcnt(0)
    v_cmp_ne_u32 vcc, 0, v8
    s_cbranch_vccnz WD_6
    s_sleep 1
    s_sub_u32 s88, s88, 1
    s_cbranch_scc0 WF_5
    s_branch L_exit
WD_6:
    s_waitcnt vmcnt(0)
    v_add_u32 v110, 1, v110
    s_getreg_b32 s62, hwreg(HW_REG_XCC_ID, 0, 4)
    ds_write_b32 v3, v110 offset:88
    s_mov_b32 s58, 0xaaaaaaaa
    s_mov_b32 s59, 0xaaaaaaaa
    v_lshrrev_b32 v125, 4, v110
    v_lshrrev_b32 v126, 8, v110
    v_lshrrev_b32 v127, 16, v110
    v_cndmask_b32 v126, v126, v127, s[58:59]
    v_lshrrev_b32 v127, 12, v110
    v_mov_b32 v113, s62
    v_cndmask_b32 v127, v127, v113, s[58:59]
    v_add_u32 v112, 8, v112
    v_add_u32 v113, 8, v116
    v_add_u32 v114, 8, v120
    v_add_u32 v115, 8, v124
    v_bfi_b32 v112, 15, v110, v112
    v_bfi_b32 v113, 15, v125, v113
PADCHAIN_2:
PAD_2:
    s_cbranch_execz WB_2
    v_bfi_b32 v114, 15, v126, v114
    v_bfi_b32 v115, 15, v127, v115
    s_lshl_b32 s53, s52, 16
    s_lshl_b32 s54, s48, 11
    s_add_u32 s53, s53, s54
    s_and_b32 s55, s49, 7
    s_lshl_b32 s55, s55, 8
    s_add_u32 s53, s53, s55
    s_add_u32 s55, s53, 1179648
    buffer_store_dwordx4 v[112:115], v106, s[16:19], s55 offen
    s_and_b32 s55, s49, 3
    s_lshl_b32 s55, s55, 14
    s_add_u32 s54, s54, s55
    s_add_u32 s55, s54, 0x10000
    s_add_u32 s56, s54, 0x20000
    s_add_u32 s57, s54, 0x30000
WF_7:
    ds_read_b32 v8, v3 offset:144
    s_waitcnt lgkmcnt(0)
    v_cmp_ne_u32 vcc, 0, v8
    s_cbranch_vccnz WD_8
    s_sleep 1
    s_sub_u32 s88, s88, 1
    s_cbranch_scc0 WF_7
    s_branch L_exit
WD_8:
    v_add_u32 v108, 1179648, v108
    s_mov_b32 s63, 0
L_qg:
    s_add_u32 s63, s63, 1
    s_cmp_lt_u32 s63, 4
    s_cbranch_scc1 L_qg2
    v_xor_b32 v108, 1179648, v108
    s_cmp_lg_u32 s63, 4
    s_cbranch_scc1 L_qg2
    buffer_store_dwordx4 v[112:115], v106, s[16:19], s53 offen sc1
L_qg2:
    buffer_load_dwordx4 v[16:19], v108, s[16:19], s54 offen offset:0 sc1
    buffer_load_dwordx4 v[20:23], v108, s[16:19], s54 offen offset:1024 sc1
    buffer_load_dwordx4 v[24:27], v108, s[16:19], s55 offen offset:0 sc1
    buffer_load_dwordx4 v[28:31], v108, s[16:19], s55 offen offset:1024 sc1
    buffer_load_dwordx4 v[32:35], v108, s[16:19], s56 offen offset:0 sc1
    buffer_load_dwordx4 v[36:39], v108, s[16:19], s56 offen offset:1024 sc1
    buffer_load_dwordx4 v[40:43], v108, s[16:19], s57 offen offset:0 sc1
    buffer_load_dwordx4 v[44:47], v108, s[16:19], s57 offen offset:1024 sc1
    s_waitcnt vmcnt(0)
    v_xor_b32 v8, v16, v110
    v_xor_b32 v119, v19, v127
    v_bitop3_b32 v8, v8, v17, v125 bitop3:0xf6
    v_bitop3_b32 v8, v8, v18, v126 bitop3:0xf6
    v_bitop3_b32 v8, v8, v20, v110 bitop3:0xf6
    v_bitop3_b32 v8, v8, v21, v125 bitop3:0xf6
    v_bitop3_b32 v8, v8, v22, v126 bitop3:0xf6
    v_bitop3_b32 v119, v119, v23, v127 bitop3:0xf6
    v_bitop3_b32 v8, v8, v24, v110 bitop3:0xf6
    v_bitop3_b32 v8, v8, v25, v125 bitop3:0xf6
    v_bitop3_b32 v8, v8, v26, v126 bitop3:0xf6
    v_bitop3_b32 v119, v119, v27, v127 bitop3:0xf6
    v_bitop3_b32 v8, v8, v28, v110 bitop3:0xf6
    v_bitop3_b32 v8, v8, v29, v125 bitop3:0xf6
    v_bitop3_b32 v8, v8, v30, v126 bitop3:0xf6
    v_bitop3_b32 v119, v119, v31, v127 bitop3:0xf6
    v_bitop3_b32 v8, v8, v32, v110 bitop3:0xf6
    v_bitop3_b32 v8, v8, v33, v125 bitop3:0xf6
    v_bitop3_b32 v8, v8, v34, v126 bitop3:0xf6
    v_bitop3_b32 v119, v119, v35, v127 bitop3:0xf6
    v_bitop3_b32 v8, v8, v36, v110 bitop3:0xf6
    v_bitop3_b32 v8, v8, v37, v125 bitop3:0xf6
    v_bitop3_b32 v8, v8, v38, v126 bitop3:0xf6
    v_bitop3_b32 v119, v119, v39, v127 bitop3:0xf6
    v_bitop3_b32 v8, v8, v40, v110 bitop3:0xf6
    v_bitop3_b32 v8, v8, v41, v125 bitop3:0xf6
    v_bitop3_b32 v8, v8, v42, v126 bitop3:0xf6
    v_bitop3_b32 v119, v119, v43, v127 bitop3:0xf6
    v_bitop3_b32 v8, v8, v44, v110 bitop3:0xf6
    v_bitop3_b32 v8, v8, v45, v125 bitop3:0xf6
    v_bitop3_b32 v8, v8, v46, v126 bitop3:0xf6
    v_bitop3_b32 v119, v119, v47, v127 bitop3:0xf6
    v_cndmask_b32 v9, v119, 0, s[58:59]
    v_or_b32 v8, v8, v9
    v_and_b32 v8, 15, v8
    v_cmp_ne_u32 vcc, 0, v8
    s_cbranch_vccnz RD_9
L_qgskip:
    v_and_b32 v16, -16, v16
    v_and_b32 v17, -16, v17
    v_and_b32 v18, -16, v18
    v_and_b32 v19, -16, v19
    v_and_b32 v20, -16, v20
    v_and_b32 v21, -16, v21
    v_and_b32 v22, -16, v22
    v_and_b32 v23, -16, v23
    v_and_b32 v24, -16, v24
    v_and_b32 v25, -16, v25
    v_and_b32 v26, -16, v26
    v_and_b32 v27, -16, v27
    v_and_b32 v28, -16, v28
    v_and_b32 v29, -16, v29
    v_and_b32 v30, -16, v30
    v_and_b32 v31, -16, v31
    v_and_b32 v32, -16, v32
    v_and_b32 v33, -16, v33
    v_and_b32 v34, -16, v34
    v_and_b32 v35, -16, v35
    v_and_b32 v36, -16, v36
    v_and_b32 v37, -16, v37
    v_and_b32 v38, -16, v38
    v_and_b32 v39, -16, v39
    v_and_b32 v40, -16, v40
    v_and_b32 v41, -16, v41
    v_and_b32 v42, -16, v42
    v_and_b32 v43, -16, v43
    v_and_b32 v44, -16, v44
    v_and_b32 v45, -16, v45
    v_and_b32 v46, -16, v46
    v_and_b32 v47, -16, v47
    v_add_f32 v80, v16, v24
    v_add_f32 v88, v32, v40
    v_add_f32 v81, v17, v25
    v_add_f32 v89, v33, v41
    v_add_f32 v82, v18, v26
    v_add_f32 v90, v34, v42
    v_add_f32 v83, v19, v27
    v_add_f32 v91, v35, v43
    v_add_f32 v84, v20, v28
    v_add_f32 v92, v36, v44
    v_add_f32 v85, v21, v29
    v_add_f32 v93, v37, v45
    v_add_f32 v86, v22, v30
    v_add_f32 v94, v38, v46
    v_add_f32 v87, v23, v31
    v_add_f32 v95, v39, v47
    v_add_f32 v80, v80, v88
    v_add_f32 v81, v81, v89
    v_add_f32 v82, v82, v90
    v_add_f32 v83, v83, v91
    v_add_f32 v84, v84, v92
    v_add_f32 v85, v85, v93
    v_add_f32 v86, v86, v94
    v_add_f32 v87, v87, v95
    v_lshlrev_b32 v9, 7, v7
    v_lshl_add_u32 v9, v12, 1, v9
    v_cvt_pk_bf16_f32 v88, v80, v81
    v_cvt_pk_bf16_f32 v89, v82, v83
    v_cvt_pk_bf16_f32 v90, v84, v85
    v_cvt_pk_bf16_f32 v91, v86, v87
    ds_write_b16 v9, v88 offset:1024
    ds_write_b16_d16_hi v9, v88 offset:1056
    ds_write_b16 v9, v89 offset:1088
    ds_write_b16_d16_hi v9, v89 offset:1120
    ds_write_b16 v9, v90 offset:1536
    ds_write_b16_d16_hi v9, v90 offset:1568
    ds_write_b16 v9, v91 offset:1600
    ds_write_b16_d16_hi v9, v91 offset:1632
    ds_write_b32 v3, v4 offset:64
    v_and_b32 v119, 15, v119
    v_cmp_ne_u32 vcc, 0, v119
    s_cmp_eq_u64 vcc, 0
    s_cselect_b32 s62, 1, 2
    v_mov_b32 v119, s62
    s_cbranch_scc1 L_quni
    buffer_store_dwordx4 v[112:115], v106, s[16:19], s53 offen sc1
L_quni:
    s_cmp_lg_u32 s49, 31
    s_cbranch_scc1 L_nogr
    s_lshl_b32 s53, s48, 2
    s_add_u32 s53, s53, 462848
    s_mov_b64 exec, 1
    buffer_store_dword v110, v10, s[16:19], s53 offen sc1
    s_mov_b64 exec, -1
L_nogr:
    s_lshl_b32 s53, s48, 2
    s_and_b32 s54, s49, 3
    s_add_u32 s53, s53, s54
    s_lshl_b32 s53, s53, 10
    s_add_u32 s53, s53, 278528
    s_lshr_b32 s54, s2, 5
    s_lshl_b32 s54, s54, 7
PAD_3:
PADSECOND_0:
    s_cbranch_execz PAD_6
    s_add_u32 s54, s54, s53
    s_mov_b32 s61, 0x3db8aa3b
    v_add_u32 v30, -4, v0
    v_lshlrev_b32 v30, 4, v30
WF_10:
    s_sub_u32 s88, s88, 1
    s_cbranch_scc1 L_exit
    ds_read_b128 v[96:99], v3 offset:32
    s_waitcnt lgkmcnt(0)
    v_and_b32 v96, v96, v97
    v_and_b32 v98, v98, v99
    v_and_b32 v96, v96, v98
    v_cmp_ne_u32 vcc, 0, v96
    s_cbranch_vccz WF_10
    ds_read_b64 v[16:17], v10 offset:2048
    s_waitcnt lgkmcnt(0)
    v_lshlrev_b32 v18, 16, v16
    v_and_b32 v19, s60, v16
    v_lshlrev_b32 v20, 16, v17
    v_and_b32 v21, s60, v17
    v_max_f32 v22, v18, v19
    v_max3_f32 v22, v22, v20, v21
    s_nop 1
    v_max_f32_dpp v22, v22, v22 quad_perm:[1,0,3,2] row_mask:0xf bank_mask:0xf
    s_nop 1
    v_max_f32_dpp v22, v22, v22 quad_perm:[2,3,0,1] row_mask:0xf bank_mask:0xf
    s_nop 1
    v_max_f32_dpp v22, v22, v22 row_half_mirror row_mask:0xf bank_mask:0xf
    v_mov_b32 v24, v22
    s_nop 1
    v_permlane16_swap_b32 v22, v24
    v_max_f32 v22, v22, v24
    v_mov_b32 v24, v22
    s_nop 1
    v_permlane32_swap_b32 v22, v24
    v_max_f32 v22, v22, v24
    v_sub_f32 v18, v18, v22
    v_mul_f32 v18, s61, v18
    v_exp_f32 v18, v18
    v_sub_f32 v19, v19, v22
    v_mul_f32 v19, s61, v19
    v_exp_f32 v19, v19
    v_sub_f32 v20, v20, v22
    v_mul_f32 v20, s61, v20
    v_exp_f32 v20, v20
    v_sub_f32 v21, v21, v22
    v_mul_f32 v21, s61, v21
    v_exp_f32 v21, v21
    s_nop 0
    v_cvt_pk_bf16_f32 v16, v18, v19
    v_cvt_pk_bf16_f32 v17, v20, v21
    ds_write_b64 v10, v[16:17] offset:2048
    ds_write_b32 v3, v119 offset:68
PAD_4:
PADSECOND_1:
    s_cbranch_execz PAD_7
    v_add_f32 v23, v18, v19
    v_add_f32 v24, v20, v21
    v_add_f32 v23, v23, v24
    s_nop 1
    v_add_f32_dpp v23, v23, v23 quad_perm:[1,0,3,2] row_mask:0xf bank_mask:0xf
    s_nop 1
    v_add_f32_dpp v23, v23, v23 quad_perm:[2,3,0,1] row_mask:0xf bank_mask:0xf
    s_nop 1
    v_add_f32_dpp v23, v23, v23 row_half_mirror row_mask:0xf bank_mask:0xf
    v_mov_b32 v24, v23
    s_nop 1
    v_permlane16_swap_b32 v23, v24
    v_add_f32 v23, v23, v24
    v_mov_b32 v24, v23
    s_nop 1
    v_permlane32_swap_b32 v23, v24
    v_add_f32 v23, v23, v24
    v_mov_b32 v24, v110
    v_mov_b32 v25, 0
    s_mov_b64 exec, 0xff0
    s_cmp_eq_u32 s62, 1
    s_cbranch_scc1 L_sloc
    buffer_store_dwordx4 v[22:25], v30, s[16:19], s54 offen sc1
    s_branch L_exit
L_sloc:
    buffer_store_dwordx4 v[22:25], v30, s[16:19], s54 offen
    s_branch L_exit
RD_9:
    s_sub_u32 s88, s88, 1
    s_cbranch_scc0 L_qg
    s_branch L_exit
L_pv:
    s_add_u32 m0, s55, 90112
    s_and_b32 s59, s59, 0xf000
    s_add_u32 s60, s53, s59
    buffer_load_dwordx4 v11, s[8:11], s60 offen nt lds
    s_addk_i32 s59, 0x1000
    s_add_u32 s57, s55, 90112
    v_lshrrev_b32 v16, 2, v0
    v_lshlrev_b32 v12, 7, v16
    v_and_b32 v17, 3, v0
    v_lshl_add_u32 v12, v17, 3, v12
    v_bfe_u32 v16, v0, 3, 2
    v_lshl_add_u32 v12, v16, 5, v12
    v_add_u32 v12, s57, v12
    v_xor_b32 v13, 32, v12
    v_xor_b32 v14, 64, v12
    v_xor_b32 v15, 0x60, v12
    s_waitcnt vmcnt(5)
    ds_write_b32 v2, v4 offset:160
    s_add_u32 m0, s55, 91136
    s_and_b32 s59, s59, 0xf000
    s_add_u32 s60, s53, s59
    buffer_load_dwordx4 v11, s[8:11], s60 offen nt lds
    s_addk_i32 s59, 0x1000
    v_bfe_u32 v20, v0, 2, 1
    v_lshlrev_b32 v22, 6, v20
    v_lshl_add_u32 v22, v7, 4, v22
    v_add_u32 v22, 2048, v22
    v_mov_b32 v21, 2560
    v_and_b32 v23, 11, v0
    v_cmp_eq_u32 vcc, 0, v23
    s_nop 1
    v_cndmask_b32 v16, v21, v22, vcc
    v_cmp_eq_u32 vcc, 1, v23
    s_nop 1
    v_cndmask_b32 v17, v21, v22, vcc
    v_cmp_eq_u32 vcc, 2, v23
    s_nop 1
    v_cndmask_b32 v18, v21, v22, vcc
    v_cmp_eq_u32 vcc, 3, v23
    s_nop 1
    v_cndmask_b32 v19, v21, v22, vcc
    s_waitcnt vmcnt(5)
    s_add_u32 m0, s55, 92160
    s_and_b32 s59, s59, 0xf000
    s_add_u32 s60, s53, s59
    buffer_load_dwordx4 v11, s[8:11], s60 offen nt lds
    s_addk_i32 s59, 0x1000
    v_and_b32 v28, 15, v0
    v_lshlrev_b32 v28, 3, v28
    v_lshl_add_u32 v28, v7, 12, v28
    s_lshl_b32 s56, s48, 2
    s_add_u32 s56, s56, s50
    s_lshl_b32 s56, s56, 13
    s_lshr_b32 s57, s49, 4
    s_lshl_b32 s57, s57, 11
    s_add_u32 s56, s56, s57
    s_and_b32 s57, s49, 3
    s_lshl_b32 s57, s57, 9
    s_add_u32 s56, s56, s57
    s_bfe_u32 s57, s49, 0x20002
    s_lshl_b32 s57, s57, 7
    s_add_u32 s56, s56, s57
    s_add_u32 s56, s56, 917504
    s_waitcnt vmcnt(5)
    s_add_u32 m0, s55, 93184
    s_and_b32 s59, s59, 0xf000
    s_add_u32 s60, s53, s59
    buffer_load_dwordx4 v11, s[8:11], s60 offen nt lds
    s_addk_i32 s59, 0x1000
    s_waitcnt vmcnt(5)
    s_add_u32 m0, s55, 94208
    s_and_b32 s59, s59, 0xf000
    s_add_u32 s60, s53, s59
    buffer_load_dwordx4 v11, s[8:11], s60 offen nt lds
    s_addk_i32 s59, 0x1000
    s_waitcnt vmcnt(5)
    ds_write_b32 v2, v4 offset:176
    s_add_u32 m0, s55, 95232
    s_and_b32 s59, s59, 0xf000
    s_add_u32 s60, s53, s59
    buffer_load_dwordx4 v11, s[8:11], s60 offen nt lds
    s_addk_i32 s59, 0x1000
    s_waitcnt vmcnt(5)
    s_add_u32 m0, s55, 96256
    s_and_b32 s59, s59, 0xf000
    s_add_u32 s60, s53, s59
    buffer_load_dwordx4 v11, s[8:11], s60 offen nt lds
    s_addk_i32 s59, 0x1000
    s_waitcnt vmcnt(5)
    s_add_u32 m0, s55, 97280
    s_and_b32 s59, s59, 0xf000
    s_add_u32 s60, s53, s59
    buffer_load_dwordx4 v11, s[8:11], s60 offen nt lds
    s_addk_i32 s59, 0x1000
    ds_read_b64_tr_b16 v[32:33], v12 offset:0
    ds_read_b64_tr_b16 v[36:37], v13 offset:0
    ds_read_b64_tr_b16 v[40:41], v14 offset:0
    ds_read_b64_tr_b16 v[44:45], v15 offset:0
    s_waitcnt vmcnt(5)
    s_add_u32 m0, s55, 98304
    s_and_b32 s59, s59, 0xf000
    s_add_u32 s60, s53, s59
    buffer_load_dwordx4 v11, s[8:11], s60 offen nt lds
    s_addk_i32 s59, 0x1000
    s_waitcnt vmcnt(5)
    s_add_u32 m0, s55, 99328
    s_and_b32 s59, s59, 0xf000
    s_add_u32 s60, s53, s59
    buffer_load_dwordx4 v11, s[8:11], s60 offen nt lds
    s_addk_i32 s59, 0x1000
    ds_read_b64_tr_b16 v[34:35], v12 offset:2048
    ds_read_b64_tr_b16 v[38:39], v13 offset:2048
    ds_read_b64_tr_b16 v[42:43], v14 offset:2048
    ds_read_b64_tr_b16 v[46:47], v15 offset:2048
    s_waitcnt vmcnt(5)
    s_add_u32 m0, s55, 100352
    s_and_b32 s59, s59, 0xf000
    s_add_u32 s60, s53, s59
    buffer_load_dwordx4 v11, s[8:11], s60 offen nt lds
    s_addk_i32 s59, 0x1000
    s_waitcnt vmcnt(5)
    s_add_u32 m0, s55, 101376
    s_and_b32 s59, s59, 0xf000
    s_add_u32 s60, s53, s59
    buffer_load_dwordx4 v11, s[8:11], s60 offen nt lds
    s_addk_i32 s59, 0x1000
    ds_read_b64_tr_b16 v[48:49], v12 offset:4096
    ds_read_b64_tr_b16 v[52:53], v13 offset:4096
    ds_read_b64_tr_b16 v[56:57], v14 offset:4096
    ds_read_b64_tr_b16 v[60:61], v15 offset:4096
    s_waitcnt vmcnt(5)
    s_add_u32 m0, s55, 102400
    s_and_b32 s59, s59, 0xf000
    s_add_u32 s60, s53, s59
    buffer_load_dwordx4 v11, s[8:11], s60 offen nt lds
    s_addk_i32 s59, 0x1000
    s_waitcnt vmcnt(5)
    s_add_u32 m0, s55, 103424
PAD_5:
PADSECOND_2:
    s_cbranch_execz PAD_8
    s_and_b32 s59, s59, 0xf000
    s_add_u32 s60, s53, s59
    buffer_load_dwordx4 v11, s[8:11], s60 offen nt lds
    s_addk_i32 s59, 0x1000
    ds_read_b64_tr_b16 v[50:51], v12 offset:6144
    ds_read_b64_tr_b16 v[54:55], v13 offset:6144
    ds_read_b64_tr_b16 v[58:59], v14 offset:6144
    ds_read_b64_tr_b16 v[62:63], v15 offset:6144
    s_waitcnt vmcnt(5)
    s_add_u32 m0, s55, 104448
    s_and_b32 s59, s59, 0xf000
    s_add_u32 s60, s53, s59
    buffer_load_dwordx4 v11, s[8:11], s60 offen nt lds
    s_addk_i32 s59, 0x1000
    s_waitcnt vmcnt(5)
    s_add_u32 m0, s55, 105472
    s_and_b32 s59, s59, 0xf000
    s_add_u32 s60, s53, s59
    buffer_load_dwordx4 v11, s[8:11], s60 offen nt lds
    ds_read_b64_tr_b16 v[132:133], v12 offset:8192
    ds_read_b64_tr_b16 v[136:137], v13 offset:8192
    ds_read_b64_tr_b16 v[140:141], v14 offset:8192
    ds_read_b64_tr_b16 v[144:145], v15 offset:8192
    s_mov_b64 exec, 0xfffffff
    buffer_load_dword v165, v30, s[28:31], s66 offen
    s_mov_b64 exec, -1
    ds_write_b32 v2, v4 offset:48
WF_1:
    s_sub_u32 s88, s88, 1
    s_cbranch_scc1 L_exit
    ds_read_b32 v8, v3 offset:68
    s_waitcnt lgkmcnt(0)
    v_cmp_ne_u32 vcc, 0, v8
    s_cbranch_vccz WF_1
    v_readfirstlane_b32 s57, v8
    ds_read_b128 v[64:67], v16 offset:0
    ds_read_b128 v[68:71], v17 offset:0
    ds_read_b128 v[72:75], v18 offset:0
    ds_read_b128 v[76:79], v19 offset:0
    ds_read_b128 v[80:83], v16 offset:128
    ds_read_b128 v[84:87], v17 offset:128
    ds_read_b128 v[88:91], v18 offset:128
    ds_read_b128 v[92:95], v19 offset:128
    ds_read_b128 v[96:99], v16 offset:256
    ds_read_b128 v[100:103], v17 offset:256
    ds_read_b128 v[104:107], v18 offset:256
    ds_read_b128 v[108:111], v19 offset:256
    ds_read_b128 v[112:115], v16 offset:384
    ds_read_b128 v[116:119], v17 offset:384
    ds_read_b128 v[120:123], v18 offset:384
    ds_read_b128 v[124:127], v19 offset:384
    s_waitcnt lgkmcnt(14)
    v_mfma_f32_16x16x32_bf16 v[128:131], v[64:67], v[32:35], 0
    s_waitcnt lgkmcnt(14)
    v_mfma_f32_16x16x32_bf16 v[128:131], v[68:71], v[36:39], v[128:131]
    s_waitcnt lgkmcnt(13)
    v_mfma_f32_16x16x32_bf16 v[128:131], v[72:75], v[40:43], v[128:131]
    s_waitcnt lgkmcnt(12)
    v_mfma_f32_16x16x32_bf16 v[128:131], v[76:79], v[44:47], v[128:131]
    s_waitcnt lgkmcnt(11)
    v_mfma_f32_16x16x32_bf16 v[128:131], v[80:83], v[48:51], v[128:131]
    s_waitcnt lgkmcnt(10)
    v_mfma_f32_16x16x32_bf16 v[128:131], v[84:87], v[52:55], v[128:131]
    s_waitcnt lgkmcnt(9)
    v_mfma_f32_16x16x32_bf16 v[128:131], v[88:91], v[56:59], v[128:131]
    s_waitcnt lgkmcnt(8)
    v_mfma_f32_16x16x32_bf16 v[128:131], v[92:95], v[60:63], v[128:131]
    s_waitcnt vmcnt(5)
    ds_read_b64_tr_b16 v[134:135], v12 offset:10240
    ds_read_b64_tr_b16 v[138:139], v13 offset:10240
    ds_read_b64_tr_b16 v[142:143], v14 offset:10240
    ds_read_b64_tr_b16 v[146:147], v15 offset:10240
    s_waitcnt vmcnt(3)
    ds_read_b64_tr_b16 v[148:149], v12 offset:12288
    ds_read_b64_tr_b16 v[152:153], v13 offset:12288
    ds_read_b64_tr_b16 v[156:157], v14 offset:12288
    ds_read_b64_tr_b16 v[160:161], v15 offset:12288
    s_waitcnt lgkmcnt(7)
    v_mfma_f32_16x16x32_bf16 v[128:131], v[96:99], v[132:135], v[128:131]
    s_waitcnt lgkmcnt(6)
    v_mfma_f32_16x16x32_bf16 v[128:131], v[100:103], v[136:139], v[128:131]
    s_waitcnt lgkmcnt(5)
    v_mfma_f32_16x16x32_bf16 v[128:131], v[104:107], v[140:143], v[128:131]
    s_waitcnt lgkmcnt(4)
    v_mfma_f32_16x16x32_bf16 v[128:131], v[108:111], v[144:147], v[128:131]
    s_waitcnt vmcnt(1)
    ds_read_b64_tr_b16 v[150:151], v12 offset:14336
    ds_read_b64_tr_b16 v[154:155], v13 offset:14336
    ds_read_b64_tr_b16 v[158:159], v14 offset:14336
    ds_read_b64_tr_b16 v[162:163], v15 offset:14336
    s_waitcnt lgkmcnt(3)
    v_mfma_f32_16x16x32_bf16 v[128:131], v[112:115], v[148:151], v[128:131]
    s_waitcnt lgkmcnt(2)
    v_mfma_f32_16x16x32_bf16 v[128:131], v[116:119], v[152:155], v[128:131]
    s_waitcnt lgkmcnt(1)
    v_mfma_f32_16x16x32_bf16 v[128:131], v[120:123], v[156:159], v[128:131]
    s_waitcnt lgkmcnt(0)
    v_mfma_f32_16x16x32_bf16 v[128:131], v[124:127], v[160:163], v[128:131]
    s_mov_b32 exec_hi, 0
    s_cmp_eq_u32 s57, 1
    s_nop 5
    v_cvt_pk_bf16_f32 v24, v128, v129
    v_cvt_pk_bf16_f32 v25, v130, v131
    v_min_u32 v24, -2, v24
    s_cbranch_scc0 L_oglob
    buffer_store_dwordx2 v[24:25], v28, s[16:19], s56 offen
L_odone:
    s_mov_b32 exec_hi, -1
    ds_write_b32 v2, v4 offset:96
    s_cmp_ge_u32 s49, 14
    s_cbranch_scc1 L_exit
    s_barrier
    s_branch L_exit
L_oglob:
    s_add_u32 s56, s56, 655360
    buffer_store_dwordx2 v[24:25], v28, s[16:19], s56 offen sc1
    ds_read_b32 v26, v3 offset:88
    s_lshl_b32 s56, s48, 2
    s_add_u32 s56, s56, s50
    s_lshl_b32 s56, s56, 5
    s_add_u32 s56, s56, s49
    s_lshl_b32 s56, s56, 2
    s_add_u32 s56, s56, 311296
    s_mov_b64 exec, 1
    s_waitcnt vmcnt(0) lgkmcnt(0)
    buffer_store_dword v26, v28, s[16:19], s56 offen sc1
    s_mov_b64 exec, -1
    s_branch L_odone
L_swave:
    v_and_b32 v12, 15, v0
    v_xor_b32 v13, v7, v12
    v_lshlrev_b32 v13, 4, v13
    v_lshl_add_u32 v13, v12, 9, v13
    s_lshl_b32 s55, s50, 14
    s_add_u32 s55, s55, 24576
    v_add_u32 v13, s55, v13
    v_xor_b32 v14, 64, v13
    v_xor_b32 v15, 0x80, v13
    v_xor_b32 v16, 0xc0, v13
    v_and_b32 v17, 1, v0
    v_lshlrev_b32 v18, 9, v17
    v_lshl_add_u32 v18, v7, 4, v18
    v_lshlrev_b32 v17, 6, v17
    v_lshl_add_u32 v17, v7, 4, v17
    s_lshl_b32 s56, s50, 7
    v_add_u32 v17, s56, v17
    s_load_dwordx2 s[28:29], s[0:1], 32
    s_mov_b32 s30, 3670016
    s_mov_b32 s31, 0x20000
    s_load_dwordx2 s[32:33], s[0:1], 64
    s_mov_b32 s34, 1605632
    s_mov_b32 s35, 0x20000
    s_load_dwordx2 s[36:37], s[0:1], 48
    s_mov_b32 s38, 1605632
    s_mov_b32 s39, 0x20000
PAD_6:
    s_cbranch_execz PAD_9
    s_load_dwordx2 s[40:41], s[0:1], 56
    s_mov_b32 s42, 3584
    s_mov_b32 s43, 0x20000
    s_cmp_lg_u32 s50, 1
    s_cbranch_scc1 L_notouch
    s_cmp_lg_u32 s49, 30
    s_cbranch_scc1 L_notouch
    s_load_dwordx4 s[72:75], s[0:1], 72
WF_12:
    ds_read_b32 v8, v2 offset:128
    s_waitcnt lgkmcnt(0)
    v_cmp_ne_u32 vcc, 0, v8
    s_cbranch_vccnz WD_13
    s_sleep 1
    s_sub_u32 s88, s88, 1
    s_cbranch_scc0 WF_12
    s_branch L_exit
WD_13:
    s_load_dword s62, s[32:33], 0
    s_load_dword s64, s[40:41], 0
    s_load_dword s60, s[72:73], 0
    s_load_dword s61, s[74:75], 0
L_notouch:
    s_lshl_b32 s56, s50, 4
    v_add_u32 v19, s56, v3
WF_14:
    ds_read_b128 v[8:11], v19 offset:128
    s_waitcnt lgkmcnt(0)
    v_and_b32 v8, v8, v9
    v_and_b32 v10, v10, v11
    v_and_b32 v8, v8, v10
    v_cmp_ne_u32 vcc, 0, v8
    s_cbranch_vccnz WD_15
    s_sleep 1
    s_sub_u32 s88, s88, 1
    s_cbranch_scc0 WF_14
    s_branch L_exit
WD_15:
    ds_read_b128 v[64:67], v13 offset:0
    ds_read_b128 v[96:99], v13 offset:8192
    ds_read_b128 v[68:71], v14 offset:0
    ds_read_b128 v[100:103], v14 offset:8192
    ds_read_b128 v[72:75], v15 offset:0
    ds_read_b128 v[104:107], v15 offset:8192
    ds_read_b128 v[76:79], v16 offset:0
    ds_read_b128 v[108:111], v16 offset:8192
    ds_read_b128 v[80:83], v13 offset:256
    ds_read_b128 v[112:115], v13 offset:8448
    ds_read_b128 v[84:87], v14 offset:256
    ds_read_b128 v[116:119], v14 offset:8448
    ds_read_b128 v[88:91], v15 offset:256
    ds_read_b128 v[120:123], v15 offset:8448
    ds_read_b128 v[92:95], v16 offset:256
    ds_read_b128 v[124:127], v16 offset:8448
WF_16:
    s_sub_u32 s88, s88, 1
    s_cbranch_scc1 L_exit
    ds_read_b32 v8, v3 offset:64
    s_waitcnt lgkmcnt(0)
    v_cmp_ne_u32 vcc, 0, v8
    s_cbranch_vccz WF_16
    ds_read_b32 v164, v3 offset:88
    ds_read_b128 v[32:35], v18 offset:1024
    ds_read_b128 v[36:39], v18 offset:1088
    ds_read_b128 v[40:43], v18 offset:1152
    ds_read_b128 v[44:47], v18 offset:1216
    ds_read_b128 v[48:51], v18 offset:1280
    ds_read_b128 v[52:55], v18 offset:1344
    ds_read_b128 v[56:59], v18 offset:1408
    ds_read_b128 v[60:63], v18 offset:1472
    s_waitcnt lgkmcnt(7)
    v_mfma_f32_16x16x32_bf16 v[20:23], v[64:67], v[32:35], 0
    v_mfma_f32_16x16x32_bf16 v[24:27], v[96:99], v[32:35], 0
    s_waitcnt lgkmcnt(6)
    v_mfma_f32_16x16x32_bf16 v[20:23], v[68:71], v[36:39], v[20:23]
    v_mfma_f32_16x16x32_bf16 v[24:27], v[100:103], v[36:39], v[24:27]
    s_waitcnt lgkmcnt(5)
    v_mfma_f32_16x16x32_bf16 v[20:23], v[72:75], v[40:43], v[20:23]
    v_mfma_f32_16x16x32_bf16 v[24:27], v[104:107], v[40:43], v[24:27]
    s_waitcnt lgkmcnt(4)
    v_mfma_f32_16x16x32_bf16 v[20:23], v[76:79], v[44:47], v[20:23]
    v_mfma_f32_16x16x32_bf16 v[24:27], v[108:111], v[44:47], v[24:27]
    s_waitcnt lgkmcnt(3)
    v_mfma_f32_16x16x32_bf16 v[20:23], v[80:83], v[48:51], v[20:23]
    v_mfma_f32_16x16x32_bf16 v[24:27], v[112:115], v[48:51], v[24:27]
    s_waitcnt lgkmcnt(2)
    v_mfma_f32_16x16x32_bf16 v[20:23], v[84:87], v[52:55], v[20:23]
    v_mfma_f32_16x16x32_bf16 v[24:27], v[116:119], v[52:55], v[24:27]
    s_waitcnt lgkmcnt(1)
    v_mfma_f32_16x16x32_bf16 v[20:23], v[88:91], v[56:59], v[20:23]
    v_mfma_f32_16x16x32_bf16 v[24:27], v[120:123], v[56:59], v[24:27]
    s_waitcnt lgkmcnt(0)
    v_mfma_f32_16x16x32_bf16 v[20:23], v[92:95], v[60:63], v[20:23]
    v_mfma_f32_16x16x32_bf16 v[24:27], v[124:127], v[60:63], v[24:27]
    s_nop 7
    v_cvt_pk_bf16_f32 v28, v20, v21
    v_cvt_pk_bf16_f32 v29, v22, v23
    v_cvt_pk_bf16_f32 v30, v24, v25
    v_cvt_pk_bf16_f32 v31, v26, v27
    s_mov_b32 exec_lo, 0x00030003
    s_mov_b32 exec_hi, 0x00030003
    ds_write_b128 v17, v[28:31] offset:2048
    s_mov_b64 exec, -1
    ds_write_b32 v2, v4 offset:32
    s_lshr_b32 s68, s50, 1
    s_and_b32 s69, s50, 1
    s_lshl_b32 s54, s48, 1
    s_add_u32 s54, s54, s68
    s_lshl_b32 s54, s54, 2
    s_add_u32 s54, s54, s69
    s_mul_i32 s54, s54, 57344
    v_and_b32 v20, 3, v6
    v_lshlrev_b32 v20, 4, v20
    v_lshrrev_b32 v21, 5, v0
    v_lshl_add_u32 v20, v21, 1, v20
    v_mul_u32_u24 v20, 896, v20
    v_add_u32 v20, v20, v5
    v_lshrrev_b32 v15, 1, v0
    v_lshlrev_b32 v15, 7, v15
    s_lshl_b32 s59, s48, 12
    s_lshl_b32 s56, s68, 6
    s_add_u32 s59, s59, s56
    s_add_u32 s59, s59, 278528
    v_readfirstlane_b32 s70, v164
    s_cmp_lt_u32 s49, 14
    s_cbranch_scc1 L_wo
    s_mov_b32 s71, s70
    s_cmp_lt_u32 s49, 25
    s_cselect_b32 s56, 7, -11
    s_add_u32 s49, s49, s56
    s_cmp_lt_u32 s49, 21
    s_cbranch_scc1 L_mlp
    s_sub_u32 s56, s49, 21
    s_lshl_b32 s56, s56, 2
    s_add_u32 s56, s56, s50
    s_mul_i32 s57, s56, 41
    v_add_u32 v9, s57, v0
    v_lshrrev_b32 v10, 2, v9
    v_mul_u32_u24 v10, 3584, v10
    v_and_b32 v9, 3, v9
    v_lshl_add_u32 v14, v9, 7, v10
    s_mul_i32 s57, s48, 448
    s_andn2_b32 s57, s57, 127
    v_lshlrev_b32 v13, 7, v0
    s_mul_i32 s56, s56, 4608
    s_mul_i32 s58, s48, 200704
    s_add_u32 s56, s56, s58
WF_18:
    s_sub_u32 s88, s88, 1
    s_cbranch_scc1 L_exit
    ds_read_b128 v[8:11], v3 offset:96
    s_waitcnt lgkmcnt(0)
    v_and_b32 v8, v8, v9
    v_and_b32 v10, v10, v11
    v_and_b32 v8, v8, v10
    v_cmp_ne_u32 vcc, 0, v8
    s_cbranch_vccz WF_18
    s_mov_b32 exec_hi, 0x1ff
    buffer_load_dword v165, v14, s[36:39], s57 offen
    s_mov_b32 exec_hi, 0xf
    buffer_load_dword v165, v13, s[32:35], s56 offen
    s_mov_b32 exec_hi, -1
    s_cmp_lt_u32 s49, 28
    s_cbranch_scc0 L_exit
    s_cmp_ge_u32 s50, 2
    s_cbranch_scc1 L_fin
    s_branch L_exit
L_wo:
    s_cmp_ge_u32 s49, 7
    s_cselect_b32 s52, 1, 0
    s_mul_i32 s53, s52, 7
    s_sub_u32 s53, s49, s53
    s_mul_i32 s56, s52, 114688
PAD_7:
    s_cbranch_execz PAD_10
    s_add_u32 s54, s54, s56
    s_lshl_b32 s56, s53, 7
    s_add_u32 s54, s54, s56
WF_20:
    s_sub_u32 s88, s88, 1
    s_cbranch_scc1 L_exit
    ds_read_b128 v[8:11], v3 offset:48
    s_waitcnt lgkmcnt(0)
    v_and_b32 v8, v8, v9
    v_and_b32 v10, v10, v11
    v_and_b32 v8, v8, v10
    v_cmp_ne_u32 vcc, 0, v8
    s_cbranch_vccz WF_20
    buffer_load_dwordx3 v[16:18], v15, s[16:19], s59 offen sc1
    s_add_u32 m0, s55, 0
    s_add_u32 s56, s54, 0
    buffer_load_dwordx4 v20, s[28:31], s56 offen lds
    s_add_u32 m0, s55, 1024
    s_add_u32 s56, s54, 3584
    buffer_load_dwordx4 v20, s[28:31], s56 offen lds
    s_add_u32 m0, s55, 2048
    s_add_u32 s56, s54, 896
    buffer_load_dwordx4 v20, s[28:31], s56 offen lds
    s_add_u32 m0, s55, 3072
    s_add_u32 s56, s54, 4480
    buffer_load_dwordx4 v20, s[28:31], s56 offen lds
    s_add_u32 m0, s55, 4096
    s_add_u32 s56, s54, 7168
    buffer_load_dwordx4 v20, s[28:31], s56 offen lds
    s_add_u32 m0, s55, 5120
    s_add_u32 s56, s54, 10752
    buffer_load_dwordx4 v20, s[28:31], s56 offen lds
    s_add_u32 m0, s55, 6144
    s_add_u32 s56, s54, 8064
    buffer_load_dwordx4 v20, s[28:31], s56 offen lds
    s_add_u32 m0, s55, 7168
    s_add_u32 s56, s54, 11648
    buffer_load_dwordx4 v20, s[28:31], s56 offen lds
    v_lshlrev_b32 v23, 2, v0
    v_and_b32 v29, 28, v23
    s_mov_b32 s61, 462848
    buffer_load_dword v31, v29, s[16:19], s61 offen sc1
    v_lshrrev_b32 v21, 2, v0
    v_lshlrev_b32 v160, 7, v21
    v_and_b32 v22, 3, v0
    v_lshl_add_u32 v160, v22, 3, v160
    v_bfe_u32 v21, v0, 3, 2
    v_lshl_add_u32 v160, v21, 5, v160
    v_add_u32 v160, s55, v160
    v_xor_b32 v161, 32, v160
    v_xor_b32 v162, 64, v160
    v_xor_b32 v163, 0x60, v160
    v_xor_b32 v21, v0, v6
    v_lshlrev_b32 v21, 4, v21
    v_and_b32 v22, 7, v0
    v_xor_b32 v12, v7, v22
    v_lshlrev_b32 v12, 4, v12
    v_and_b32 v22, 15, v0
    v_lshl_add_u32 v12, v22, 7, v12
    s_add_u32 s72, s55, 8192
    v_add_u32 v12, s72, v12
    v_xor_b32 v13, 64, v12
    v_and_b32 v22, 3, v0
    s_lshl_b32 s57, s48, 2
    s_lshl_b32 s56, s52, 1
    s_add_u32 s57, s57, s56
    s_add_u32 s57, s57, s69
    s_lshl_b32 s57, s57, 1
    s_add_u32 s57, s57, s68
    s_lshl_b32 s57, s57, 12
    s_add_u32 s57, s57, 917504
    s_mov_b32 s69, 0x3db8aa3b
    s_lshl_b32 s56, s50, 10
    v_add_u32 v24, s56, v23
    v_add_u32 v24, 4096, v24
    v_lshrrev_b32 v25, 5, v0
    v_lshlrev_b32 v25, 8, v25
    v_bfe_u32 v26, v0, 2, 3
    v_lshl_add_u32 v25, v26, 3, v25
    v_and_b32 v26, 1, v0
    v_lshl_add_u32 v25, v26, 2, v25
    s_lshl_b32 s56, s50, 6
    s_add_u32 s56, s56, 4096
    v_add_u32 v25, s56, v25
    v_cmp_eq_u32 vcc, 2, v22
    v_mov_b32 v26, 1.0
    s_lshl_b32 s58, s50, 15
    v_cndmask_b32 v26, 0, v26, vcc
    s_lshl_b32 s56, s53, 12
    s_add_u32 s58, s58, s56
    s_add_u32 s58, s58, 1441792
    v_and_b32 v23, 0x7c, v23
    v_lshrrev_b32 v22, 5, v0
    v_lshl_add_u32 v23, v22, 10, v23
    v_mov_b32 v27, v26
    v_lshlrev_b32 v30, 10, v0
    s_lshl_b32 s60, s48, 2
    s_lshl_b32 s62, s52, 7
    s_add_u32 s60, s60, s62
    s_lshl_b32 s62, s53, 13
    s_add_u32 s60, s60, s62
    s_lshl_b32 s62, s50, 8
    s_add_u32 s60, s60, s62
    s_add_u32 s60, s60, 327680
    s_waitcnt vmcnt(9)
    v_cmp_ne_u32 vcc, v18, v164
    s_cbranch_vccnz L_stwait
L_stok:
    v_mov_b32 v19, v16
    s_nop 1
    v_max_f32_dpp v19, v19, v19 row_ror:8 row_mask:0xf bank_mask:0xf
    s_nop 1
    v_max_f32_dpp v19, v19, v19 row_ror:4 row_mask:0xf bank_mask:0xf
    s_nop 1
    v_max_f32_dpp v19, v19, v19 row_ror:2 row_mask:0xf bank_mask:0xf
    s_nop 1
    v_sub_f32 v16, v16, v19
    v_mul_f32 v16, s69, v16
    v_exp_f32 v16, v16
    s_nop 0
    v_mul_f32 v17, v17, v16
    s_nop 1
    v_add_f32_dpp v17, v17, v17 row_ror:8 row_mask:0xf bank_mask:0xf
    s_nop 1
    v_add_f32_dpp v17, v17, v17 row_ror:4 row_mask:0xf bank_mask:0xf
    s_nop 1
    v_add_f32_dpp v17, v17, v17 row_ror:2 row_mask:0xf bank_mask:0xf
    s_nop 1
    v_rcp_f32 v17, v17
    s_nop 0
    v_mul_f32 v16, v16, v17
    s_nop 1
    v_mov_b32_dpp v96, v16 row_newbcast:0 row_mask:0xf bank_mask:0xf
    v_mov_b32_dpp v97, v16 row_newbcast:2 row_mask:0xf bank_mask:0xf
    v_mov_b32_dpp v98, v16 row_newbcast:4 row_mask:0xf bank_mask:0xf
    v_mov_b32_dpp v99, v16 row_newbcast:6 row_mask:0xf bank_mask:0xf
    v_mov_b32_dpp v100, v16 row_newbcast:8 row_mask:0xf bank_mask:0xf
    v_mov_b32_dpp v101, v16 row_newbcast:10 row_mask:0xf bank_mask:0xf
    v_mov_b32_dpp v102, v16 row_newbcast:12 row_mask:0xf bank_mask:0xf
    v_mov_b32_dpp v103, v16 row_newbcast:14 row_mask:0xf bank_mask:0xf
    ds_read_b32 v8, v3 offset:68
    s_waitcnt lgkmcnt(0)
    v_cmp_ne_u32 vcc, 1, v8
    s_cbranch_vccnz L_wglob
L_wgok:
    s_mov_b32 m0, s72
    s_nop 0
    buffer_load_dwordx4 v21, s[16:19], s57 offen offset:0 sc1 lds
    buffer_load_dwordx4 v21, s[16:19], s57 offen offset:1024 sc1 lds
    buffer_load_dwordx4 v21, s[16:19], s57 offen offset:2048 sc1 lds
    buffer_load_dwordx4 v21, s[16:19], s57 offen offset:3072 sc1 lds
    s_waitcnt vmcnt(5)
    ds_read_b64_tr_b16 v[128:129], v160 offset:0
    ds_read_b64_tr_b16 v[130:131], v160 offset:2048
    ds_read_b64_tr_b16 v[132:133], v161 offset:0
    ds_read_b64_tr_b16 v[134:135], v161 offset:2048
    ds_read_b64_tr_b16 v[136:137], v162 offset:0
    ds_read_b64_tr_b16 v[138:139], v162 offset:2048
    ds_read_b64_tr_b16 v[140:141], v163 offset:0
    ds_read_b64_tr_b16 v[142:143], v163 offset:2048
    ds_read_b64_tr_b16 v[144:145], v160 offset:4096
    ds_read_b64_tr_b16 v[146:147], v160 offset:6144
    ds_read_b64_tr_b16 v[148:149], v161 offset:4096
    ds_read_b64_tr_b16 v[150:151], v161 offset:6144
    ds_read_b64_tr_b16 v[152:153], v162 offset:4096
    ds_read_b64_tr_b16 v[154:155], v162 offset:6144
PAD_8:
    s_cbranch_execz PAD_11
    ds_read_b64_tr_b16 v[156:157], v163 offset:4096
    ds_read_b64_tr_b16 v[158:159], v163 offset:6144
OP_22:
    s_xor_b32 m0, m0, 0x1000
    s_nop 0
    buffer_load_dwordx4 v21, s[16:19], s57 offen offset:0 sc1 lds
    buffer_load_dwordx4 v21, s[16:19], s57 offen offset:1024 sc1 lds
    buffer_load_dwordx4 v21, s[16:19], s57 offen offset:2048 sc1 lds
    buffer_load_dwordx4 v21, s[16:19], s57 offen offset:3072 sc1 lds
    s_waitcnt vmcnt(4)
    ds_read_b128 v[32:35], v12 offset:0
    ds_read_b128 v[36:39], v12 offset:2048
    ds_read_b128 v[40:43], v13 offset:0
    ds_read_b128 v[44:47], v13 offset:2048
    v_xor_b32 v12, 0x1000, v12
    v_xor_b32 v13, 0x1000, v13
    s_waitcnt lgkmcnt(3)
    v_mfma_f32_16x16x32_bf16 v[64:67], v[32:35], v[128:131], 0
    s_waitcnt lgkmcnt(2)
    v_mfma_f32_16x16x32_bf16 v[68:71], v[36:39], v[128:131], 0
    v_max3_u32 v28, v32, v34, v36
    s_waitcnt lgkmcnt(1)
    v_mfma_f32_16x16x32_bf16 v[64:67], v[40:43], v[144:147], v[64:67]
    v_max3_u32 v14, v38, v40, v42
    s_waitcnt lgkmcnt(0)
    v_mfma_f32_16x16x32_bf16 v[68:71], v[44:47], v[144:147], v[68:71]
    v_max3_u32 v28, v28, v44, v46
    v_max_u32 v28, v28, v14
    v_cmp_eq_u32 vcc, -1, v28
    v_mfma_f32_16x16x32_bf16 v[72:75], v[32:35], v[132:135], 0
    s_cbranch_vccnz RD_23
    v_mfma_f32_16x16x32_bf16 v[76:79], v[36:39], v[132:135], 0
    v_mfma_f32_16x16x32_bf16 v[72:75], v[40:43], v[148:151], v[72:75]
    v_mul_f32 v48, v64, v96
    v_mul_f32 v49, v68, v100
    v_mfma_f32_16x16x32_bf16 v[76:79], v[44:47], v[148:151], v[76:79]
    v_fmac_f32 v48, v65, v97
    v_fmac_f32 v49, v69, v101
PAD_9:
    s_cbranch_execz PAD_12
    v_mfma_f32_16x16x32_bf16 v[80:83], v[32:35], v[136:139], 0
    v_fmac_f32 v48, v66, v98
    v_fmac_f32 v49, v70, v102
    v_mfma_f32_16x16x32_bf16 v[84:87], v[36:39], v[136:139], 0
    v_fmac_f32 v48, v67, v99
    v_fmac_f32 v49, v71, v103
    v_mfma_f32_16x16x32_bf16 v[80:83], v[40:43], v[152:155], v[80:83]
    v_mul_f32 v52, v72, v96
    v_mul_f32 v53, v76, v100
    v_add_f32 v48, v48, v49
    v_mfma_f32_16x16x32_bf16 v[84:87], v[44:47], v[152:155], v[84:87]
    v_fmac_f32 v52, v73, v97
    v_fmac_f32 v53, v77, v101
    v_mfma_f32_16x16x32_bf16 v[88:91], v[32:35], v[140:143], 0
    v_fmac_f32 v52, v74, v98
    v_fmac_f32 v53, v78, v102
    v_mfma_f32_16x16x32_bf16 v[92:95], v[36:39], v[140:143], 0
    v_fmac_f32 v52, v75, v99
    v_fmac_f32 v53, v79, v103
    v_mfma_f32_16x16x32_bf16 v[88:91], v[40:43], v[156:159], v[88:91]
    v_mul_f32 v56, v80, v96
    v_mul_f32 v57, v84, v100
    v_mfma_f32_16x16x32_bf16 v[92:95], v[44:47], v[156:159], v[92:95]
    v_fmac_f32 v56, v81, v97
    v_fmac_f32 v57, v85, v101
    v_add_f32 v52, v52, v53
    v_fmac_f32 v56, v82, v98
    v_fmac_f32 v57, v86, v102
    ds_write2st64_b32 v24, v48, v52 offset0:0 offset1:1
    v_fmac_f32 v56, v83, v99
    v_fmac_f32 v57, v87, v103
    v_cmp_ne_u32 vcc, v31, v164
    v_add_f32 v56, v56, v57
    v_mul_f32 v60, v88, v96
    v_mul_f32 v61, v92, v100
    v_fmac_f32 v60, v89, v97
    v_fmac_f32 v61, v93, v101
    v_fmac_f32 v60, v90, v98
    v_fmac_f32 v61, v94, v102
    v_fmac_f32 v60, v91, v99
    v_fmac_f32 v61, v95, v103
    v_add_f32 v60, v60, v61
    ds_write2st64_b32 v24, v56, v60 offset0:2 offset1:3
    s_cbranch_vccnz L_grwait
L_grok:
    s_waitcnt lgkmcnt(0)
    s_barrier
    ds_read2st64_b32 v[32:33], v25 offset0:0 offset1:4
    ds_read2st64_b32 v[34:35], v25 offset0:8 offset1:12
    ds_read2st64_b32 v[36:37], v25 offset0:2 offset1:6
    ds_read2st64_b32 v[38:39], v25 offset0:10 offset1:14
    s_mov_b64 exec, 0xff
    buffer_store_dword v164, v30, s[16:19], s60 offen sc1
    s_mov_b64 exec, -1
    s_mov_b32 exec_lo, 0x33333333
    s_mov_b32 exec_hi, 0x33333333
    s_waitcnt lgkmcnt(2)
    v_add_f32 v32, v32, v33
    v_add_f32 v34, v34, v35
    v_add_f32 v26, v32, v34
    s_waitcnt lgkmcnt(0)
    v_add_f32 v36, v36, v37
    v_add_f32 v38, v38, v39
    v_add_f32 v27, v36, v38
    s_mov_b64 exec, -1
    buffer_atomic_add_f32 v26, v23, s[16:19], s58 offen
    buffer_atomic_add_f32 v27, v23, s[16:19], s58 offen offset:2048
    s_branch L_exit
L_grwait:
    buffer_load_dword v31, v29, s[16:19], s61 offen sc1
    s_waitcnt vmcnt(0)
    v_cmp_ne_u32 vcc, v31, v164
    s_cbranch_vccnz RD_24
    s_branch L_grok
L_stwait:
    s_sleep 1
    buffer_load_dwordx3 v[16:18], v15, s[16:19], s59 offen sc1
    s_waitcnt vmcnt(0)
    v_cmp_ne_u32 vcc, v18, v164
    s_cbranch_vccnz RD_25
    s_branch L_stok
L_wglob:
    s_sub_u32 s56, s57, 917504
    s_lshr_b32 s56, s56, 13
    s_lshl_b32 s56, s56, 7
    s_add_u32 s56, s56, 311296
    s_add_u32 s57, s57, 655360
    v_lshlrev_b32 v9, 2, v0
    v_and_b32 v9, 0x7c, v9
L_wg2:
    buffer_load_dword v8, v9, s[16:19], s56 offen sc1
    s_waitcnt vmcnt(0)
    v_cmp_ne_u32 vcc, v8, v164
    s_cbranch_vccnz RD_26
    s_branch L_wgok
RD_23:
    s_sub_u32 s88, s88, 1
    s_cbranch_scc0 OP_22
    s_branch L_exit
RD_24:
    s_sub_u32 s88, s88, 1
    s_cbranch_scc0 L_grwait
    s_branch L_exit
RD_25:
    s_sub_u32 s88, s88, 1
    s_cbranch_scc0 L_stwait
    s_branch L_exit
RD_26:
    s_sub_u32 s88, s88, 1
    s_cbranch_scc0 L_wg2
    s_branch L_exit
L_mlp:
    s_mul_i32 s52, s48, 7
    s_add_u32 s52, s52, s49
    s_sub_u32 s52, s52, 14
    v_and_b32 v22, 3, v0
    v_mul_u32_u24 v21, 896, v6
    v_add_u32 v21, v21, v5
    s_mul_i32 s56, s52, 28672
    s_lshl_b32 s57, s50, 7
    s_add_u32 s56, s56, s57
    s_add_u32 s54, s55, 65536
    v_bfe_u32 v15, v0, 2, 2
    v_lshlrev_b32 v18, 6, v15
    v_lshl_add_u32 v18, v7, 4, v18
    v_add_u32 v18, 8192, v18
    v_mov_b32 v19, 2560
    v_cmp_eq_u32 vcc, 0, v22
    s_nop 1
    v_cndmask_b32 v24, v19, v18, vcc
    v_cmp_eq_u32 vcc, 1, v22
    s_nop 1
    v_cndmask_b32 v25, v19, v18, vcc
    v_cmp_eq_u32 vcc, 2, v22
    s_nop 1
    v_cndmask_b32 v26, v19, v18, vcc
    v_cmp_eq_u32 vcc, 3, v22
    s_nop 1
    v_cndmask_b32 v27, v19, v18, vcc
    v_lshrrev_b32 v8, 2, v0
    v_lshlrev_b32 v160, 7, v8
    v_and_b32 v9, 3, v0
    v_lshl_add_u32 v160, v9, 3, v160
    v_bfe_u32 v8, v0, 3, 2
    v_lshl_add_u32 v160, v8, 5, v160
    v_add_u32 v160, s54, v160
    v_xor_b32 v161, 32, v160
    v_xor_b32 v162, 64, v160
    v_xor_b32 v163, 0x60, v160
    s_mul_i32 s58, s52, 7168
    s_lshl_b32 s59, s50, 10
    s_add_u32 s58, s58, s59
    s_add_u32 s58, s58, 466944
    s_add_u32 s62, s58, 4096
    v_lshlrev_b32 v23, 4, v0
    s_cmp_ge_u32 s50, 2
    s_cbranch_scc1 L_mlp_b
    v_lshrrev_b32 v13, 2, v0
    v_mul_u32_u24 v20, 3584, v13
    v_lshl_add_u32 v20, v22, 4, v20
    v_lshlrev_b32 v13, 6, v13
    v_lshl_add_u32 v13, v22, 3, v13
    s_lshl_b32 s57, s50, 5
    s_add_u32 s53, s57, 24576
    v_add_u32 v13, s53, v13
    s_lshl_b32 s59, s52, 6
    s_add_u32 s57, s57, s59
    s_mul_i32 s53, s50, 802816
    s_add_u32 s59, s59, s53
    v_lshlrev_b32 v9, 1, v12
    buffer_load_ushort v28, v9, s[40:43], s57 offen
    v_mul_u32_u24 v16, 896, v15
    v_lshl_add_u32 v16, v7, 4, v16
    v_add_u32 v16, 4096, v16
    v_cmp_eq_u32 vcc, 1, v22
    v_mov_b32 v9, 9216
    v_lshlrev_b32 v17, 6, v7
    v_cndmask_b32 v16, v16, v9, vcc
    v_lshl_add_u32 v17, v15, 4, v17
    v_lshl_add_u32 v17, v22, 1, v17
    s_lshl_b32 s53, s50, 3
    s_add_u32 s53, s53, 8192
    v_add_u32 v17, s53, v17
    v_lshlrev_b32 v14, 3, v7
    v_mov_b32 v8, 0x3f803f80
    v_mov_b32 v9, v8
    v_mov_b32 v10, v8
    v_mov_b32 v11, v8
    ds_write_b128 v23, v[8:11] offset:9216
WF_27:
    s_sub_u32 s88, s88, 1
    s_cbranch_scc1 L_exit
    ds_read_b128 v[96:99], v3 offset:96
PAD_10:
    s_cbranch_execz PAD_13
    s_waitcnt lgkmcnt(0)
    v_and_b32 v96, v96, v97
    v_and_b32 v98, v98, v99
    v_and_b32 v96, v96, v98
    v_cmp_ne_u32 vcc, 0, v96
    s_cbranch_vccz WF_27
    s_add_u32 m0, s55, 0
    s_add_u32 s53, s59, 0
    buffer_load_dwordx4 v20, s[36:39], s53 offen lds
    s_add_u32 m0, s55, 1024
    s_add_u32 s53, s59, 57344
    buffer_load_dwordx4 v20, s[36:39], s53 offen lds
    s_add_u32 m0, s55, 2048
    s_add_u32 s53, s59, 114688
    buffer_load_dwordx4 v20, s[36:39], s53 offen lds
    s_add_u32 m0, s55, 3072
    s_add_u32 s53, s59, 172032
    buffer_load_dwordx4 v20, s[36:39], s53 offen lds
    s_add_u32 m0, s55, 4096
    s_add_u32 s53, s59, 229376
    buffer_load_dwordx4 v20, s[36:39], s53 offen lds
    s_add_u32 m0, s55, 5120
    s_add_u32 s53, s59, 286720
    buffer_load_dwordx4 v20, s[36:39], s53 offen lds
    s_add_u32 m0, s55, 6144
    s_add_u32 s53, s59, 344064
    buffer_load_dwordx4 v20, s[36:39], s53 offen lds
    s_add_u32 m0, s55, 7168
    s_add_u32 s53, s59, 401408
    buffer_load_dwordx4 v20, s[36:39], s53 offen lds
    s_add_u32 m0, s55, 8192
    s_add_u32 s53, s59, 458752
    buffer_load_dwordx4 v20, s[36:39], s53 offen lds
    s_add_u32 m0, s55, 9216
    s_add_u32 s53, s59, 516096
    buffer_load_dwordx4 v20, s[36:39], s53 offen lds
    s_add_u32 m0, s55, 10240
    s_add_u32 s53, s59, 573440
    buffer_load_dwordx4 v20, s[36:39], s53 offen lds
    s_add_u32 m0, s55, 11264
    s_add_u32 s53, s59, 630784
    buffer_load_dwordx4 v20, s[36:39], s53 offen lds
    s_add_u32 m0, s55, 12288
    s_add_u32 s53, s59, 688128
    buffer_load_dwordx4 v20, s[36:39], s53 offen lds
    s_add_u32 m0, s55, 13312
    s_add_u32 s53, s59, 745472
    buffer_load_dwordx4 v20, s[36:39], s53 offen lds
    s_add_u32 m0, s54, 0
    s_add_u32 s53, s56, 0
    buffer_load_dwordx4 v21, s[32:35], s53 offen lds
    s_add_u32 m0, s54, 1024
    s_add_u32 s53, s56, 7168
    buffer_load_dwordx4 v21, s[32:35], s53 offen lds
    s_add_u32 m0, s54, 2048
    s_add_u32 s53, s56, 14336
    buffer_load_dwordx4 v21, s[32:35], s53 offen lds
    s_add_u32 m0, s54, 3072
    s_add_u32 s53, s56, 21504
    buffer_load_dwordx4 v21, s[32:35], s53 offen lds
    s_add_u32 m0, s54, 4096
    s_add_u32 s53, s56, 512
    buffer_load_dwordx4 v21, s[32:35], s53 offen lds
    s_add_u32 m0, s54, 5120
    s_add_u32 s53, s56, 7680
    buffer_load_dwordx4 v21, s[32:35], s53 offen lds
    s_add_u32 m0, s54, 6144
    s_add_u32 s53, s56, 14848
    buffer_load_dwordx4 v21, s[32:35], s53 offen lds
    s_add_u32 m0, s54, 7168
    s_add_u32 s53, s56, 22016
    buffer_load_dwordx4 v21, s[32:35], s53 offen lds
    s_waitcnt vmcnt(8)
    ds_write_b32 v2, v4 offset:16
    v_xor_b32 v9, 4, v2
WF_29:
    s_sub_u32 s88, s88, 1
    s_cbranch_scc1 L_exit
    ds_read_b32 v8, v9 offset:16
    s_waitcnt lgkmcnt(0)
    v_cmp_ne_u32 vcc, 0, v8
    s_cbranch_vccz WF_29
    ds_read_b64_tr_b16 v[64:65], v13 offset:0
    ds_read_b64_tr_b16 v[66:67], v13 offset:1024
    ds_read_b64_tr_b16 v[68:69], v13 offset:2048
    ds_read_b64_tr_b16 v[70:71], v13 offset:3072
    ds_read_b64_tr_b16 v[72:73], v13 offset:4096
    ds_read_b64_tr_b16 v[74:75], v13 offset:5120
    ds_read_b64_tr_b16 v[76:77], v13 offset:6144
    ds_read_b64_tr_b16 v[78:79], v13 offset:7168
    ds_read_b64_tr_b16 v[80:81], v13 offset:8192
    ds_read_b64_tr_b16 v[82:83], v13 offset:9216
    ds_read_b64_tr_b16 v[84:85], v13 offset:10240
    ds_read_b64_tr_b16 v[86:87], v13 offset:11264
    ds_read_b64_tr_b16 v[88:89], v13 offset:12288
    ds_read_b64_tr_b16 v[90:91], v13 offset:13312
    ds_read_b64_tr_b16 v[92:93], v13 offset:16384
    ds_read_b64_tr_b16 v[94:95], v13 offset:17408
    ds_read_b64_tr_b16 v[96:97], v13 offset:18432
    ds_read_b64_tr_b16 v[98:99], v13 offset:19456
    ds_read_b64_tr_b16 v[100:101], v13 offset:20480
    ds_read_b64_tr_b16 v[102:103], v13 offset:21504
    ds_read_b64_tr_b16 v[104:105], v13 offset:22528
    ds_read_b64_tr_b16 v[106:107], v13 offset:23552
    ds_read_b64_tr_b16 v[108:109], v13 offset:24576
    ds_read_b64_tr_b16 v[110:111], v13 offset:25600
    ds_read_b64_tr_b16 v[112:113], v13 offset:26624
    ds_read_b64_tr_b16 v[114:115], v13 offset:27648
    ds_read_b64_tr_b16 v[116:117], v13 offset:28672
    ds_read_b64_tr_b16 v[118:119], v13 offset:29696
    v_lshlrev_b32 v28, 16, v28
    s_waitcnt vmcnt(0)
    ds_read_b64_tr_b16 v[120:121], v160 offset:0
    ds_read_b64_tr_b16 v[122:123], v160 offset:2048
    ds_read_b64_tr_b16 v[124:125], v161 offset:0
    ds_read_b64_tr_b16 v[126:127], v161 offset:2048
    ds_read_b64_tr_b16 v[128:129], v162 offset:0
    ds_read_b64_tr_b16 v[130:131], v162 offset:2048
    ds_read_b64_tr_b16 v[132:133], v163 offset:0
    ds_read_b64_tr_b16 v[134:135], v163 offset:2048
    ds_read_b64_tr_b16 v[136:137], v160 offset:4096
    ds_read_b64_tr_b16 v[138:139], v160 offset:6144
    ds_read_b64_tr_b16 v[140:141], v161 offset:4096
    ds_read_b64_tr_b16 v[142:143], v161 offset:6144
    ds_read_b64_tr_b16 v[144:145], v162 offset:4096
    ds_read_b64_tr_b16 v[146:147], v162 offset:6144
    ds_read_b64_tr_b16 v[148:149], v163 offset:4096
    ds_read_b64_tr_b16 v[150:151], v163 offset:6144
    s_waitcnt lgkmcnt(0)
    s_barrier
    ds_read_b128 v[8:11], v16 offset:0
PAD_11:
    s_cbranch_execz PAD_14
    ds_read_b128 v[32:35], v16 offset:64
    ds_read_b128 v[36:39], v16 offset:128
    ds_read_b128 v[40:43], v16 offset:192
    ds_read_b128 v[44:47], v16 offset:256
    ds_read_b128 v[48:51], v16 offset:320
    ds_read_b128 v[52:55], v16 offset:384
    ds_read_b128 v[56:59], v16 offset:448
    ds_read_b128 v[60:63], v16 offset:512
    ds_read_b128 v[156:159], v16 offset:576
    ds_read_b128 v[160:163], v16 offset:640
    s_waitcnt lgkmcnt(10)
    v_mfma_f32_16x16x32_bf16 v[152:155], v[8:11], v[64:67], 0
    s_waitcnt lgkmcnt(9)
    v_mfma_f32_16x16x32_bf16 v[152:155], v[32:35], v[68:71], v[152:155]
    s_waitcnt lgkmcnt(8)
    v_mfma_f32_16x16x32_bf16 v[152:155], v[36:39], v[72:75], v[152:155]
    ds_read_b128 v[8:11], v16 offset:704
    ds_read_b128 v[32:35], v16 offset:768
    ds_read_b128 v[36:39], v16 offset:832
    s_waitcnt lgkmcnt(10)
    v_mfma_f32_16x16x32_bf16 v[152:155], v[40:43], v[76:79], v[152:155]
    s_waitcnt lgkmcnt(9)
    v_mfma_f32_16x16x32_bf16 v[152:155], v[44:47], v[80:83], v[152:155]
    s_waitcnt lgkmcnt(8)
    v_mfma_f32_16x16x32_bf16 v[152:155], v[48:51], v[84:87], v[152:155]
    s_waitcnt lgkmcnt(7)
    v_mfma_f32_16x16x32_bf16 v[152:155], v[52:55], v[88:91], v[152:155]
    s_waitcnt lgkmcnt(6)
    v_mfma_f32_16x16x32_bf16 v[152:155], v[56:59], v[92:95], v[152:155]
    s_waitcnt lgkmcnt(5)
    v_mfma_f32_16x16x32_bf16 v[152:155], v[60:63], v[96:99], v[152:155]
    s_waitcnt lgkmcnt(4)
    v_mfma_f32_16x16x32_bf16 v[152:155], v[156:159], v[100:103], v[152:155]
    s_waitcnt lgkmcnt(3)
    v_mfma_f32_16x16x32_bf16 v[152:155], v[160:163], v[104:107], v[152:155]
    s_waitcnt lgkmcnt(0)
    s_barrier
    ds_read_b64 v[30:31], v14 offset:8704
    v_mfma_f32_16x16x32_bf16 v[152:155], v[8:11], v[108:111], v[152:155]
    v_mfma_f32_16x16x32_bf16 v[152:155], v[32:35], v[112:115], v[152:155]
    v_mfma_f32_16x16x32_bf16 v[152:155], v[36:39], v[116:119], v[152:155]
    s_mov_b32 s64, 0xbdd2d3e8
    v_mov_b32 v9, 0xc0135761
    s_nop 4
    s_waitcnt lgkmcnt(0)
    v_fma_f32 v28, -v31, v153, v28
    v_fmac_f32 v28, v152, v30
    v_mul_f32 v8, v28, v28
    v_fma_f32 v8, v8, s64, v9
    v_mul_f32 v8, v8, v28
    v_exp_f32 v8, v8
    s_nop 0
    v_add_f32 v8, 1.0, v8
    v_rcp_f32 v8, v8
    s_nop 0
    v_mul_f32 v8, v8, v28
    v_cvt_pk_bf16_f32 v8, v8, v8
    ds_write_b16 v17, v8
    s_waitcnt lgkmcnt(0)
L_mlp2:
    s_barrier
    ds_read_b128 v[32:35], v24
    ds_read_b128 v[36:39], v25
    ds_read_b128 v[40:43], v26
    ds_read_b128 v[44:47], v27
    s_waitcnt lgkmcnt(3)
    v_mfma_f32_16x16x32_bf16 v[48:51], v[32:35], v[120:123], 0
    v_mfma_f32_16x16x32_bf16 v[52:55], v[32:35], v[136:139], 0
    s_waitcnt lgkmcnt(2)
    v_mfma_f32_16x16x32_bf16 v[48:51], v[36:39], v[124:127], v[48:51]
    v_mfma_f32_16x16x32_bf16 v[52:55], v[36:39], v[140:143], v[52:55]
    s_waitcnt lgkmcnt(1)
    v_mfma_f32_16x16x32_bf16 v[48:51], v[40:43], v[128:131], v[48:51]
    v_mfma_f32_16x16x32_bf16 v[52:55], v[40:43], v[144:147], v[52:55]
    s_waitcnt lgkmcnt(0)
    v_mfma_f32_16x16x32_bf16 v[48:51], v[44:47], v[132:135], v[48:51]
    v_mfma_f32_16x16x32_bf16 v[52:55], v[44:47], v[148:151], v[52:55]
    v_mov_b32 v58, v164
    v_mov_b32 v59, v164
    v_mov_b32 v62, v164
    v_mov_b32 v63, v164
    s_nop 2
    v_cvt_pk_bf16_f32 v56, v48, v49
    v_cvt_pk_bf16_f32 v57, v50, v51
    buffer_store_dwordx4 v[56:59], v23, s[16:19], s58 offen sc1
    s_cmp_eq_u32 s50, 3
    s_cbranch_scc1 L_exit
    v_cvt_pk_bf16_f32 v60, v52, v53
    v_cvt_pk_bf16_f32 v61, v54, v55
    buffer_store_dwordx4 v[60:63], v23, s[16:19], s62 offen sc1
    s_branch L_exit
L_mlp_b:
    v_lshlrev_b32 v9, 2, v0
    s_mul_i32 s57, s50, 896
    s_sub_u32 s59, s57, 1792
    s_mov_b32 exec_hi, 0x00ffffff
    buffer_load_dword v36, v9, s[20:23], s57 offen offset:0
    buffer_load_dword v37, v9, s[20:23], s57 offen offset:224
    buffer_load_dword v38, v9, s[20:23], s57 offen offset:448
    buffer_load_dword v39, v9, s[20:23], s57 offen offset:672
    buffer_load_dword v156, v9, s[20:23], s59 offen offset:0
    buffer_load_dword v157, v9, s[20:23], s59 offen offset:224
    buffer_load_dword v158, v9, s[20:23], s59 offen offset:448
    buffer_load_dword v159, v9, s[20:23], s59 offen offset:672
    s_mov_b32 exec_hi, -1
    s_add_u32 s59, s59, 4096
    v_add_u32 v8, 0, v0
    v_lshrrev_b32 v9, 4, v8
    v_lshlrev_b32 v9, 6, v9
    v_bfe_u32 v10, v8, 1, 2
    v_lshl_add_u32 v9, v10, 4, v9
    v_and_b32 v10, 8, v8
    v_add_u32 v9, v9, v10
    v_and_b32 v10, 1, v8
    v_lshl_add_u32 v9, v10, 2, v9
    v_add_u32 v32, s59, v9
    v_add_u32 v8, 56, v0
    v_lshrrev_b32 v9, 4, v8
    v_lshlrev_b32 v9, 6, v9
    v_bfe_u32 v10, v8, 1, 2
    v_lshl_add_u32 v9, v10, 4, v9
    v_and_b32 v10, 8, v8
    v_add_u32 v9, v9, v10
    v_and_b32 v10, 1, v8
    v_lshl_add_u32 v9, v10, 2, v9
    v_add_u32 v33, s59, v9
    v_add_u32 v8, 112, v0
    v_lshrrev_b32 v9, 4, v8
    v_lshlrev_b32 v9, 6, v9
    v_bfe_u32 v10, v8, 1, 2
    v_lshl_add_u32 v9, v10, 4, v9
    v_and_b32 v10, 8, v8
    v_add_u32 v9, v9, v10
    v_and_b32 v10, 1, v8
    v_lshl_add_u32 v9, v10, 2, v9
    v_add_u32 v34, s59, v9
    v_add_u32 v8, 168, v0
    v_lshrrev_b32 v9, 4, v8
    v_lshlrev_b32 v9, 6, v9
    v_bfe_u32 v10, v8, 1, 2
    v_lshl_add_u32 v9, v10, 4, v9
    v_and_b32 v10, 8, v8
    v_add_u32 v9, v9, v10
    v_and_b32 v10, 1, v8
    v_lshl_add_u32 v9, v10, 2, v9
    v_add_u32 v35, s59, v9
    s_lshl_b32 s53, s50, 3
    v_mov_b32 v15, s53
    s_lshl_b32 s57, s50, 15
    s_add_u32 s57, s57, 1441792
    s_sub_u32 s61, s57, 65536
    v_and_b32 v92, 0x70, v23
    v_lshl_add_u32 v92, v6, 10, v92
    v_add_u32 v93, 7168, v92
    v_add_u32 v94, 14336, v92
    v_add_u32 v95, 21504, v92
PAD_12:
    s_cbranch_execz PAD_15
    v_and_b32 v16, 32, v0
    v_add_u32 v16, v16, v0
    v_lshlrev_b32 v16, 10, v16
    s_mov_b32 s66, 1441792
    s_mov_b32 s67, 1474560
    s_mov_b32 s59, 0x41800000
    s_lshl_b32 s63, s52, 10
    s_add_u32 s63, s63, 327680
    s_add_u32 s64, s16, s63
    s_addc_u32 s65, s17, 0
    v_lshrrev_b32 v19, 1, v0
    v_mul_u32_u24 v19, 3584, v19
    v_and_b32 v18, 1, v0
    v_lshl_add_u32 v19, v18, 7, v19
    s_sub_u32 s63, s49, 14
    s_lshl_b32 s63, s63, 9
    s_lshl_b32 s53, s48, 2
    s_add_u32 s63, s63, s53
    s_and_b32 s53, s50, 1
    s_lshl_b32 s53, s53, 8
    s_add_u32 s63, s63, s53
    s_add_u32 s63, s63, 393216
    s_mov_b32 s60, 0xffff0000
    v_mov_b32 v88, 0
    v_mov_b32 v89, 0
    v_mov_b32 v90, 0
    v_mov_b32 v91, 0
WF_31:
    s_sub_u32 s88, s88, 1
    s_cbranch_scc1 L_exit
    ds_read_b128 v[96:99], v3 offset:96
    s_waitcnt lgkmcnt(0)
    v_and_b32 v96, v96, v97
    v_and_b32 v98, v98, v99
    v_and_b32 v96, v96, v98
    v_cmp_ne_u32 vcc, 0, v96
    s_cbranch_vccz WF_31
    s_add_u32 m0, s54, 0
    s_add_u32 s53, s56, 0
    buffer_load_dwordx4 v21, s[32:35], s53 offen lds
    s_add_u32 m0, s54, 1024
    s_add_u32 s53, s56, 7168
    buffer_load_dwordx4 v21, s[32:35], s53 offen lds
    s_add_u32 m0, s54, 2048
    s_add_u32 s53, s56, 14336
    buffer_load_dwordx4 v21, s[32:35], s53 offen lds
    s_add_u32 m0, s54, 3072
    s_add_u32 s53, s56, 21504
    buffer_load_dwordx4 v21, s[32:35], s53 offen lds
    s_cmp_eq_u32 s50, 3
    s_cselect_b32 s56, 0x7f000000, s56
    s_add_u32 m0, s54, 4096
    s_add_u32 s53, s56, 512
    buffer_load_dwordx4 v21, s[32:35], s53 offen lds
    s_add_u32 m0, s54, 5120
    s_add_u32 s53, s56, 7680
    buffer_load_dwordx4 v21, s[32:35], s53 offen lds
    s_add_u32 m0, s54, 6144
    s_add_u32 s53, s56, 14848
    buffer_load_dwordx4 v21, s[32:35], s53 offen lds
    s_add_u32 m0, s54, 7168
    s_add_u32 s53, s56, 22016
    buffer_load_dwordx4 v21, s[32:35], s53 offen lds
    s_waitcnt vmcnt(8)
    v_lshlrev_b32 v40, 16, v36
    v_and_b32 v41, s60, v36
    v_lshlrev_b32 v104, 16, v156
    v_and_b32 v105, s60, v156
    v_lshlrev_b32 v42, 16, v37
    v_and_b32 v43, s60, v37
    v_lshlrev_b32 v106, 16, v157
    v_and_b32 v107, s60, v157
    v_lshlrev_b32 v44, 16, v38
    v_and_b32 v45, s60, v38
    v_lshlrev_b32 v108, 16, v158
    v_and_b32 v109, s60, v158
    v_lshlrev_b32 v46, 16, v39
    v_and_b32 v47, s60, v39
    v_lshlrev_b32 v110, 16, v159
    v_and_b32 v111, s60, v159
    s_cmp_lg_u32 s50, 3
    s_cbranch_scc1 L_gow
    s_add_u32 s68, s64, 128
    s_addc_u32 s69, s65, 0
    s_mov_b32 s89, 0
    s_load_dwordx8 s[72:79], s[64:65], s89 glc
    s_load_dwordx8 s[80:87], s[68:69], s89 glc
    s_waitcnt lgkmcnt(0)
PH_33:
    s_sub_u32 s88, s88, 1
    s_cbranch_scc1 L_exit
    s_add_u32 s89, s89, 256
    s_and_b32 s89, s89, 1023
    s_load_dwordx8 s[72:79], s[64:65], s89 glc
    s_load_dwordx8 s[80:87], s[68:69], s89 glc
    s_sleep 1
    s_cmp_lg_u64 s[72:73], s[70:71]
    s_cbranch_scc1 PH_33
    s_cmp_lg_u64 s[74:75], s[70:71]
    s_cbranch_scc1 PH_33
    s_cmp_lg_u64 s[76:77], s[70:71]
    s_cbranch_scc1 PH_33
    s_cmp_lg_u64 s[78:79], s[70:71]
    s_cbranch_scc1 PH_33
    s_cmp_lg_u64 s[80:81], s[70:71]
    s_cbranch_scc1 PH_33
    s_cmp_lg_u64 s[82:83], s[70:71]
    s_cbranch_scc1 PH_33
    s_cmp_lg_u64 s[84:85], s[70:71]
    s_cbranch_scc1 PH_33
    s_cmp_lg_u64 s[86:87], s[70:71]
    s_cbranch_scc1 PH_33
    ds_write_b32 v3, v4 offset:80
    s_mov_b32 exec_lo, 0x0fffffff
    s_mov_b32 exec_hi, 0x0fffffff
    buffer_load_dword v165, v16, s[16:19], s66 offen sc1
    s_mov_b32 exec_lo, -1
    s_branch L_hp
L_gow:
WF_34:
    s_sub_u32 s88, s88, 1
    s_cbranch_scc1 L_exit
    ds_read_b32 v8, v3 offset:80
    s_waitcnt lgkmcnt(0)
    v_cmp_ne_u32 vcc, 0, v8
    s_cbranch_vccz WF_34
L_hp:
    s_mov_b32 exec_hi, 0x00ffffff
    buffer_load_dwordx4 v[48:51], v92, s[16:19], s57 offen sc1
    buffer_load_dwordx4 v[52:55], v93, s[16:19], s57 offen sc1
    buffer_load_dwordx4 v[56:59], v94, s[16:19], s57 offen sc1
    buffer_load_dwordx4 v[60:63], v95, s[16:19], s57 offen sc1
    buffer_load_dwordx4 v[64:67], v92, s[16:19], s61 offen sc1
    buffer_load_dwordx4 v[68:71], v93, s[16:19], s61 offen sc1
    buffer_load_dwordx4 v[72:75], v94, s[16:19], s61 offen sc1
    buffer_load_dwordx4 v[76:79], v95, s[16:19], s61 offen sc1
    s_mov_b32 exec_hi, -1
    s_waitcnt vmcnt(8)
    ds_read_b64_tr_b16 v[120:121], v160 offset:0
    ds_read_b64_tr_b16 v[122:123], v160 offset:2048
    ds_read_b64_tr_b16 v[124:125], v161 offset:0
    ds_read_b64_tr_b16 v[126:127], v161 offset:2048
    ds_read_b64_tr_b16 v[128:129], v162 offset:0
    ds_read_b64_tr_b16 v[130:131], v162 offset:2048
    ds_read_b64_tr_b16 v[132:133], v163 offset:0
    ds_read_b64_tr_b16 v[134:135], v163 offset:2048
    ds_read_b64_tr_b16 v[136:137], v160 offset:4096
    ds_read_b64_tr_b16 v[138:139], v160 offset:6144
    ds_read_b64_tr_b16 v[140:141], v161 offset:4096
    ds_read_b64_tr_b16 v[142:143], v161 offset:6144
    ds_read_b64_tr_b16 v[144:145], v162 offset:4096
    ds_read_b64_tr_b16 v[146:147], v162 offset:6144
    ds_read_b64_tr_b16 v[148:149], v163 offset:4096
    ds_read_b64_tr_b16 v[150:151], v163 offset:6144
    s_mov_b32 exec_hi, 0x00ffffff
    s_waitcnt vmcnt(4)
    v_pk_add_f32 v[48:49], v[48:49], v[40:41]
    v_cvt_pk_bf16_f32 v36, v48, v49
    ds_write_b32 v32, v36 offset:1792
    v_pk_add_f32 v[52:53], v[52:53], v[42:43]
    v_cvt_pk_bf16_f32 v37, v52, v53
    ds_write_b32 v33, v37 offset:1792
    v_pk_add_f32 v[56:57], v[56:57], v[44:45]
    v_cvt_pk_bf16_f32 v38, v56, v57
    ds_write_b32 v34, v38 offset:1792
PAD_13:
    s_cbranch_execz L_warmdone
    v_pk_add_f32 v[60:61], v[60:61], v[46:47]
    v_cvt_pk_bf16_f32 v39, v60, v61
    ds_write_b32 v35, v39 offset:1792
    v_min_f32 v8, v50, v54
    v_min3_f32 v8, v8, v58, v62
    s_waitcnt vmcnt(0)
    v_pk_add_f32 v[64:65], v[64:65], v[104:105]
    v_cvt_pk_bf16_f32 v156, v64, v65
    ds_write_b32 v32, v156
    v_pk_add_f32 v[68:69], v[68:69], v[106:107]
    v_cvt_pk_bf16_f32 v157, v68, v69
    ds_write_b32 v33, v157
    v_pk_add_f32 v[72:73], v[72:73], v[108:109]
    v_cvt_pk_bf16_f32 v158, v72, v73
    ds_write_b32 v34, v158
    v_pk_add_f32 v[76:77], v[76:77], v[110:111]
    v_cvt_pk_bf16_f32 v159, v76, v77
    ds_write_b32 v35, v159
    v_min3_f32 v8, v8, v66, v70
    v_min3_f32 v8, v8, v74, v78
    v_cmp_neq_f32 vcc, s59, v8
    s_cbranch_vccnz RD_36
    v_pk_add_f32 v[80:81], v[48:49], v[52:53]
    v_pk_mul_f32 v[82:83], v[48:49], v[48:49]
    v_pk_add_f32 v[84:85], v[64:65], v[68:69]
    v_pk_mul_f32 v[86:87], v[64:65], v[64:65]
    s_waitcnt lgkmcnt(0)
    s_barrier
    v_pk_add_f32 v[80:81], v[80:81], v[56:57]
    v_pk_fma_f32 v[82:83], v[52:53], v[52:53], v[82:83]
    v_pk_add_f32 v[84:85], v[84:85], v[72:73]
    v_pk_fma_f32 v[86:87], v[68:69], v[68:69], v[86:87]
    v_pk_add_f32 v[80:81], v[80:81], v[60:61]
    v_pk_fma_f32 v[82:83], v[56:57], v[56:57], v[82:83]
    v_pk_add_f32 v[84:85], v[84:85], v[76:77]
PAD_14:
    s_cbranch_execz L_warmdone
    v_pk_fma_f32 v[86:87], v[72:73], v[72:73], v[86:87]
    v_pk_fma_f32 v[82:83], v[60:61], v[60:61], v[82:83]
    v_pk_fma_f32 v[86:87], v[76:77], v[76:77], v[86:87]
    v_add_f32 v88, v80, v81
    v_add_f32 v90, v84, v85
    v_add_f32 v89, v82, v83
    v_add_f32 v91, v86, v87
    s_mov_b32 exec_hi, -1
    s_mov_b64 exec, 0xffff
    buffer_store_dword v164, v19, s[16:19], s63 offen sc1
    s_mov_b64 exec, -1
    s_nop 0
    v_permlane32_swap_b32 v88, v89
    v_permlane32_swap_b32 v90, v91
    v_add_f32 v8, v88, v89
    v_add_f32 v10, v90, v91
    s_nop 1
    v_permlane16_swap_b32 v8, v10
    v_add_f32 v8, v8, v10
    s_nop 1
    v_add_f32_dpp v8, v8, v8 row_ror:8 row_mask:0xf bank_mask:0xf
    s_nop 1
    v_add_f32_dpp v8, v8, v8 row_ror:4 row_mask:0xf bank_mask:0xf
    s_nop 1
    v_add_f32_dpp v8, v8, v8 row_ror:2 row_mask:0xf bank_mask:0xf
    s_nop 1
    v_add_f32_dpp v8, v8, v8 row_ror:1 row_mask:0xf bank_mask:0xf
    s_nop 1
    v_mul_f32 v8, 0x3b124925, v8
    v_mov_b32 v9, v8
    s_mov_b32 s64, 0x3727c5ac
    v_and_b32 v10, 16, v0
    v_permlane32_swap_b32 v8, v9
    v_fma_f32 v9, -v8, v8, v9
    v_max_f32 v9, 0, v9
    v_add_f32 v11, s64, v9
    v_rsq_f32 v11, v11
    v_xor_b32 v15, v15, v10
    v_mul_f32 v9, v9, v11
    v_fma_f32 v9, v9, v11, s64
    v_rsq_f32 v9, v9
    s_mov_b32 exec_lo, 0x00010001
    s_mov_b32 exec_hi, 0
    v_mul_f32 v30, v9, v11
    v_mul_f32 v31, v30, v8
    ds_write_b64 v15, v[30:31] offset:8704
    s_mov_b64 exec, -1
    s_waitcnt lgkmcnt(0)
    s_barrier
    s_lshl_b32 s53, s52, 2
    s_add_u32 s53, s53, s50
    s_cmp_lg_u32 s53, 3
    s_cbranch_scc1 L_mlp2
    s_mov_b32 s53, 463104
    s_mov_b64 exec, 1
    buffer_store_dword v164, v23, s[16:19], s53 offen sc1
    s_mov_b64 exec, -1
    s_branch L_mlp2
RD_36:
    s_sub_u32 s88, s88, 1
    s_cbranch_scc0 L_hp
    s_branch L_exit
RD_39:
    s_sub_u32 s88, s88, 1
    s_cbranch_scc0 FP_38
    s_branch L_exit
L_fin:
    s_load_dwordx2 s[40:41], s[0:1], 72
    s_mov_b32 s42, 896
    s_mov_b32 s43, 0x20000
    s_load_dwordx2 s[44:45], s[0:1], 80
    s_mov_b32 s46, 3584
    s_mov_b32 s47, 0x20000
    s_mul_i32 s52, s48, 7
    s_add_u32 s52, s52, s49
    s_lshl_b32 s52, s52, 1
    s_add_u32 s52, s52, s50
    s_sub_u32 s52, s52, 44
    s_lshl_b32 s53, s52, 6
    s_add_u32 s53, s53, 466944
    s_add_u32 s54, s53, 114688
    s_add_u32 s55, s53, 229376
    s_add_u32 s56, s53, 344064
    v_lshrrev_b32 v20, 2, v0
    v_mul_u32_u24 v20, 7168, v20
    v_and_b32 v22, 3, v0
    v_lshl_add_u32 v20, v22, 4, v20
    s_lshr_b32 s57, s52, 4
    s_lshl_b32 s57, s57, 6
    s_and_b32 s58, s52, 3
    s_lshl_b32 s58, s58, 2
    s_add_u32 s57, s57, s58
    v_and_b32 v23, 16, v0
    v_lshlrev_b32 v23, 1, v23
    v_lshrrev_b32 v24, 5, v0
    v_lshl_add_u32 v23, v24, 4, v23
    v_add3_u32 v23, v23, v22, s57
    v_lshlrev_b32 v24, 1, v23
    v_bfe_u32 v25, v23, 1, 3
    v_lshlrev_b32 v25, 4, v25
    v_lshrrev_b32 v26, 4, v23
    v_lshl_add_u32 v25, v26, 10, v25
    s_bfe_u32 s58, s52, 0x20002
    s_mul_i32 s59, s58, 896
    s_lshl_b32 s58, s58, 15
    s_add_u32 s58, s58, 1441792
    s_mov_b32 s61, 0x41800000
    v_mov_b32 v44, 0
    v_mov_b32 v45, 0
    v_mov_b32 v46, v164
    s_mov_b32 s60, 0xffff0000
    s_waitcnt lgkmcnt(0)
    buffer_load_ushort v26, v24, s[20:23], s59 offen
    buffer_load_ushort v27, v24, s[40:43], 0 offen
    buffer_load_ushort v28, v24, s[44:47], s59 offen
    s_lshr_b32 s63, s52, 1
    s_lshl_b32 s63, s63, 9
    s_add_u32 s63, s63, 393216
    s_add_u32 s64, s16, s63
    s_addc_u32 s65, s17, 0
    v_and_b32 v8, 1, v0
    v_cmp_eq_u32 s[66:67], 1, v8
    s_waitcnt vmcnt(0)
    v_lshlrev_b32 v26, 16, v26
    v_lshlrev_b32 v27, 16, v27
    v_add_f32 v26, v26, v27
    s_cmp_lg_u32 s50, 3
    s_cbranch_scc1 L_fhbar
    s_mov_b32 s89, 0
    s_load_dwordx8 s[72:79], s[64:65], s89 glc
    s_waitcnt lgkmcnt(0)
PH_37:
    s_sub_u32 s88, s88, 1
    s_cbranch_scc1 L_exit
    s_add_u32 s89, s89, 128
    s_and_b32 s89, s89, 511
    s_load_dwordx8 s[72:79], s[64:65], s89 glc
    s_sleep 1
    s_cmp_lg_u64 s[72:73], s[70:71]
    s_cbranch_scc1 PH_37
    s_cmp_lg_u64 s[74:75], s[70:71]
    s_cbranch_scc1 PH_37
    s_cmp_lg_u64 s[76:77], s[70:71]
    s_cbranch_scc1 PH_37
    s_cmp_lg_u64 s[78:79], s[70:71]
    s_cbranch_scc1 PH_37
L_fhbar:
    s_barrier
FP_38:
    buffer_load_dwordx4 v[28:31], v25, s[16:19], s58 offen sc1
    buffer_load_dwordx4 v[32:35], v20, s[16:19], s53 offen sc1
    buffer_load_dwordx4 v[36:39], v20, s[16:19], s54 offen sc1
    buffer_load_dwordx4 v[40:43], v20, s[16:19], s55 offen sc1
    s_mov_b32 exec_hi, 0
    buffer_load_dwordx4 v[44:47], v20, s[16:19], s56 offen sc1
    s_mov_b32 exec_hi, -1
    s_waitcnt vmcnt(4)
    v_cndmask_b32 v28, v28, v29, s[66:67]
    v_add_f32 v27, v26, v28
    v_cmp_neq_f32 s[68:69], s61, v30
    s_waitcnt vmcnt(3)
    v_lshlrev_b32 v48, 16, v32
    v_and_b32 v49, s60, v32
    v_lshlrev_b32 v50, 16, v33
    v_and_b32 v51, s60, v33
    v_xor_b32 v8, v34, v164
    s_waitcnt vmcnt(2)
    v_lshlrev_b32 v52, 16, v36
    v_and_b32 v53, s60, v36
    v_lshlrev_b32 v54, 16, v37
    v_and_b32 v55, s60, v37
    v_bitop3_b32 v8, v8, v38, v164 bitop3:0xf6
    v_pk_add_f32 v[48:49], v[48:49], v[52:53]
    v_pk_add_f32 v[50:51], v[50:51], v[54:55]
    s_waitcnt vmcnt(1)
    v_lshlrev_b32 v52, 16, v40
    v_and_b32 v53, s60, v40
    v_lshlrev_b32 v54, 16, v41
    v_and_b32 v55, s60, v41
    v_bitop3_b32 v8, v8, v42, v164 bitop3:0xf6
    v_pk_add_f32 v[48:49], v[48:49], v[52:53]
    v_pk_add_f32 v[50:51], v[50:51], v[54:55]
    s_waitcnt vmcnt(0)
    v_lshlrev_b32 v52, 16, v44
    v_and_b32 v53, s60, v44
PAD_15:
    s_cbranch_execz L_warmdone
    v_lshlrev_b32 v54, 16, v45
    v_and_b32 v55, s60, v45
    v_pk_add_f32 v[32:33], v[48:49], v[52:53]
    v_pk_add_f32 v[34:35], v[50:51], v[54:55]
    v_bitop3_b32 v8, v8, v46, v164 bitop3:0xf6
    v_cmp_ne_u32 vcc, 0, v8
    s_or_b64 vcc, vcc, s[68:69]
    s_cbranch_vccnz RD_39
    v_permlane32_swap_b32 v32, v33
    v_permlane32_swap_b32 v34, v35
    v_add_f32 v32, v32, v33
    v_add_f32 v34, v34, v35
    s_nop 1
    v_permlane16_swap_b32 v32, v34
    v_add_f32 v32, v32, v34
    s_nop 1
    v_add_f32_dpp v32, v32, v32 row_ror:4 row_mask:0xf bank_mask:0xf
    s_nop 1
    v_add_f32_dpp v32, v32, v32 row_ror:8 row_mask:0xf bank_mask:0xf
    v_add_f32 v32, v32, v27
    v_cvt_pk_bf16_f32 v32, v32, v32
    s_mov_b32 exec_lo, 0x000f000f
    s_mov_b32 exec_hi, 0x000f000f
    buffer_store_short v32, v24, s[44:47], s59 offen
L_exit:
L_end:
    s_endpgm
.section .rodata,"a"
.p2align 6
.amdhsa_kernel sequential_preLN__sliding_block_cached__mixer_channel_mlp__decode_kernel
  .amdhsa_next_free_vgpr 168
  .amdhsa_next_free_sgpr 96
  .amdhsa_accum_offset 168
  .amdhsa_group_segment_fixed_size 0
  .amdhsa_kernarg_size 104
  .amdhsa_user_sgpr_count 2
  .amdhsa_user_sgpr_kernarg_segment_ptr 1
  .amdhsa_system_sgpr_workgroup_id_x 1
.end_amdhsa_kernel
```
